```python
import torch

def _softmax(x, axis=-1):
    return torch.softmax(x, dim=axis)
def _gelu(x):
    return torch.nn.functional.gelu(x, approximate="tanh")
def _silu(x):
    return torch.nn.functional.silu(x)
def _sigmoid(x):
    return torch.sigmoid(x)
def _layernorm(x, axis=-1, eps=1e-5):
    m = x.mean(dim=axis, keepdim=True)
    v = x.var(dim=axis, keepdim=True, unbiased=False)
    return (x - m) / torch.sqrt(v + eps)
def _scatter_add(tgt, idx, src, axis=0):
    return tgt.clone().index_add_(axis, idx, src)
def _segment_sum(src, seg, n):
    out = torch.zeros((n,) + src.shape[1:], dtype=src.dtype)
    return out.index_add_(0, seg, src)
def _pad(x, pw):
    flat = tuple(v for pair in reversed(pw) for v in pair)
    return torch.nn.functional.pad(x, flat)

kernel_name = 'gated_mix__softmax_full_mha__dense_activation_silu__prompt'

def setup_inputs():

    _w = (lambda a: (lambda t: t.to(torch.bfloat16) if t.is_floating_point() else t)(torch.as_tensor(a)))
    def _A_setup():
        B, S, D = 1, 2048, 512
        return {
            "x": _w((lambda *s: torch.randn(*s, dtype=torch.bfloat16) * 0.05)(B, S, D)),
            "wqkv": _w((lambda *s: torch.randn(*s, dtype=torch.bfloat16) * 0.8)(D, 3 * D)),
            "wo": _w((lambda *s: torch.randn(*s, dtype=torch.bfloat16) * 0.05)(D, D)),
        }
    _A_in = _A_setup()

    def _B_setup():
        B, S, D, F = 1, 2048, 512, 1792
        return {
            "x": _w((lambda *s: torch.randn(*s, dtype=torch.bfloat16) * 0.05)(B, S, D)),
            "w1": _w((lambda *s: torch.randn(*s, dtype=torch.bfloat16) * 3.2)(D, F) * (D ** -0.5)),
            "w2": _w((lambda *s: torch.randn(*s, dtype=torch.bfloat16) * 0.8)(F, D) * (F ** -0.5)),
        }
    _B_in = _B_setup()

    return {
        "A_x": _A_in["x"],
        "A_wqkv": _A_in["wqkv"],
        "A_wo": _A_in["wo"],
        "B_x": _B_in["x"],
        "B_w1": _B_in["w1"],
        "B_w2": _B_in["w2"],
        "gate_w": _w((lambda *s: torch.randn(*s, dtype=torch.bfloat16) * 0.05)(512) * 16.0),
    }

def reference(A_x, A_wqkv, A_wo, B_x, B_w1, B_w2, gate_w):
    def _A_ref(x, wqkv, wo):
        B, S, D = x.shape
        H = 32; Dh = D // H
        qkv = (lambda x, *d: x.permute(*d))((x @ wqkv).reshape(B, S, 3, H, Dh), 2, 0, 3, 1, 4)
        q, k, v = qkv[0], qkv[1], qkv[2]
        scale = Dh ** -0.5
        scores = torch.einsum("bhqd,bhkd->bhqk", q, k) * scale
        p = _softmax(scores, axis=-1)
        o = torch.einsum("bhqk,bhkd->bhqd", p, v)
        return (lambda x, *d: x.permute(*d))(o, 0, 2, 1, 3).reshape(B, S, D) @ wo

    def _B_ref(x, w1, w2):
        h = torch.einsum("bsd,df->bsf", x, w1)
        h = _silu(h)
        out = torch.einsum("bsf,fd->bsd", h, w2)
        return out

    x = A_x
    g = _sigmoid((x * gate_w).sum(-1, keepdims=True))
    a = _A_ref(x, A_wqkv, A_wo)
    b = _B_ref(x, B_w1, B_w2)
    return g * a + (1 - g) * b
```

```asm
; @launch grid=(256,1,1) block=(512,1,1) lds=160832
.amdgcn_target "amdgcn-amd-amdhsa--gfx950"
.text
.p2align 8
.globl gated_mix__softmax_full_mha__dense_activation_silu__prompt_kernel
.type gated_mix__softmax_full_mha__dense_activation_silu__prompt_kernel,@function
gated_mix__softmax_full_mha__dense_activation_silu__prompt_kernel:
  s_cmp_ge_u32 s2, 256
  s_cbranch_scc1 F_end
  s_load_dwordx4 s[4:7], s[0:1], 0
  s_load_dwordx2 s[8:9], s[0:1], 16
  s_load_dwordx4 s[12:15], s[0:1], 32
  s_load_dwordx4 s[16:19], s[0:1], 64
  s_load_dwordx4 s[92:95], s[0:1], 48
  v_lshrrev_b32 v1, 6, v0
  v_and_b32 v2, 63, v0
  s_getpc_b64 s[68:69]
F_pc:
  s_sub_u32 s68, s68, F_pc-gated_mix__softmax_full_mha__dense_activation_silu__prompt_kernel
  s_subb_u32 s69, s69, 0
  s_lshr_b32 s70, s2, 3
  s_lshl_b32 s70, s70, 11
  v_lshlrev_b32 v4, 8, v1
  v_lshl_add_u32 v4, v2, 6, v4
  v_add_u32 v4, s70, v4
  v_min_u32 v4, F_last-gated_mix__softmax_full_mha__dense_activation_silu__prompt_kernel-4, v4
  s_mov_b64 exec, 15
  global_load_dword v255, v4, s[68:69]
  s_mov_b64 exec, -1
  v_readfirstlane_b32 s48, v1
  s_and_b32 s53, s2, 1
  s_lshl_b32 s53, s53, 3
  s_bfe_u32 s54, s2, 0x30003
  s_add_u32 s49, s53, s54
  s_bfe_u32 s53, s2, 0x20001
  s_lshl_b32 s53, s53, 2
  s_lshr_b32 s54, s2, 6
  s_add_u32 s50, s53, s54
  s_lshl_b32 s53, s50, 1
  s_add_u32 s53, s53, s49
  s_and_b32 s52, s53, 7
  s_and_b32 s51, s48, 3
  v_lshlrev_b32 v3, 4, v2
  s_cmp_lt_u32 s48, 4
  s_cbranch_scc1 F_i0
  v_mul_u32_u24 v17, 5462, v2
  v_lshrrev_b32 v17, 16, v17
  v_mul_u32_u24 v17, 2880, v17
  v_lshl_add_u32 v4, v2, 4, v17
  v_add_u32 v16, 64, v2
  v_mul_u32_u24 v17, 5462, v16
  v_lshrrev_b32 v17, 16, v17
  v_mul_u32_u24 v17, 2880, v17
  v_lshl_add_u32 v5, v16, 4, v17
  v_add_u32 v16, 128, v2
  v_mul_u32_u24 v17, 5462, v16
  v_lshrrev_b32 v17, 16, v17
  v_mul_u32_u24 v17, 2880, v17
  v_lshl_add_u32 v6, v16, 4, v17
  s_mul_i32 s55, s51, 49152
  s_mul_i32 s61, s50, 192
  s_add_u32 s55, s55, s61
  s_mul_i32 s56, s51, 3072
  s_mul_i32 s58, s52, 196608
  s_add_u32 s58, s58, s55
  s_waitcnt lgkmcnt(0)
  s_mov_b32 s24, s6
  s_and_b32 s25, s7, 0xffff
  s_mov_b32 s26, 1572864
  s_mov_b32 s27, 0x20000
  s_add_u32 m0, s56, 73728
  s_nop 0
  buffer_load_dwordx4 v4, s[24:27], s58 offen lds
  s_add_u32 m0, s56, 74752
  s_nop 0
  buffer_load_dwordx4 v5, s[24:27], s58 offen lds
  s_add_u32 m0, s56, 75776
  s_nop 0
  buffer_load_dwordx4 v6, s[24:27], s58 offen lds
  s_mov_b32 s44, s92
  s_and_b32 s45, s93, 0xffff
  s_mov_b32 s46, 1024
  s_mov_b32 s47, 0x20000
  s_mov_b32 m0, 143360
  s_nop 0
  buffer_load_dwordx4 v3, s[44:47], 0 offen lds
  s_branch F_g1
F_i0:
  v_lshrrev_b32 v16, 3, v2
  v_and_b32 v17, 7, v2
  v_lshrrev_b32 v18, 4, v2
  v_xor_b32 v17, v17, v18
  v_lshlrev_b32 v17, 4, v17
  v_lshl_add_u32 v4, v16, 10, v17
  v_xor_b32 v5, 64, v4
  s_lshl_b32 s55, s49, 17
  s_lshl_b32 s61, s51, 15
  s_add_u32 s55, s55, s61
  s_lshl_b32 s56, s51, 12
  s_lshl_b32 s58, s52, 7
  s_add_u32 s58, s58, s55
  s_waitcnt lgkmcnt(0)
  s_mov_b32 s20, s4
  s_and_b32 s21, s5, 0xffff
  s_mov_b32 s22, 2097152
  s_mov_b32 s23, 0x20000
  s_add_u32 m0, s56, 57344
  s_add_u32 s57, s58, 0
  buffer_load_dwordx4 v4, s[20:23], s57 offen lds
  s_add_u32 m0, s56, 58368
  s_add_u32 s57, s58, 8192
  buffer_load_dwordx4 v5, s[20:23], s57 offen lds
  s_add_u32 m0, s56, 59392
  s_add_u32 s57, s58, 16384
  buffer_load_dwordx4 v4, s[20:23], s57 offen lds
  s_add_u32 m0, s56, 60416
  s_add_u32 s57, s58, 24576
  buffer_load_dwordx4 v5, s[20:23], s57 offen lds
  s_mov_b32 s32, s18
  s_and_b32 s33, s19, 0xffff
  s_mov_b32 s34, 33554432
  s_mov_b32 s35, 0x20000
  s_mov_b32 s28, s12
  s_and_b32 s29, s13, 0xffff
  s_mov_b32 s30, 1835008
  s_mov_b32 s31, 0x20000
  s_mov_b32 s80, s16
  s_and_b32 s81, s17, 0xffff
  s_mov_b32 s82, 256
  s_mov_b32 s83, 0x20000
  s_and_b32 s61, s50, 3
  s_and_b32 s63, s49, 1
  s_cmp_eq_u32 s61, 2
  s_cselect_b32 s66, 1, 0
  s_lshl_b32 s61, s61, 3
  s_lshl_b32 s63, s63, 2
  s_add_u32 s61, s61, s63
  s_lshr_b32 s64, 0x65442210, s61
  s_and_b32 s64, s64, 15
  s_lshr_b32 s65, 0x56333301, s61
  s_and_b32 s65, s65, 15
  s_sub_u32 s100, s65, s64
  s_lshl_b32 s100, s100, 7
  s_lshr_b32 s67, s50, 2
  s_mul_i32 s59, s67, 896
  s_lshl_b32 s63, s64, 7
  s_add_u32 s59, s59, s63
  s_mul_i32 s63, s51, 28672
  s_add_u32 s59, s59, s63
  s_lshl_b32 s60, s51, 10
  s_lshl_b32 s62, s52, 1
  s_lshl_b32 s68, s49, 2
  s_add_u32 s68, s68, s51
  s_mul_i32 s68, s68, 112
  s_mul_i32 s67, s67, 28
  s_add_u32 s68, s68, s67
  s_lshl_b32 s64, s64, 2
  s_add_u32 s64, s64, s68
  s_lshl_b32 s64, s64, 10
  s_add_u32 s84, s64, 6291456
  s_mov_b32 s101, s84
  v_lshrrev_b32 v16, 3, v2
  v_and_b32 v17, 7, v2
  v_bfe_u32 v18, v2, 4, 1
  v_lshlrev_b32 v18, 2, v18
  v_xor_b32 v17, v17, v18
  v_lshlrev_b32 v17, 4, v17
  v_mul_u32_u24 v16, 3584, v16
  v_add_u32 v7, v16, v17
  v_and_b32 v32, 31, v2
  v_lshrrev_b32 v33, 5, v2
  v_bfe_u32 v34, v2, 1, 3
  v_xor_b32 v34, v34, v33
  v_lshlrev_b32 v34, 4, v34
  s_lshl_b32 s61, s51, 12
  s_add_u32 s61, s61, 57344
  v_lshl_add_u32 v34, v32, 7, v34
  v_add_u32 v10, s61, v34
  v_xor_b32 v11, 32, v10
  v_xor_b32 v12, 64, v10
  v_xor_b32 v13, 96, v10
  v_bfe_u32 v34, v2, 2, 2
  v_lshl_add_u32 v34, v33, 3, v34
  v_and_b32 v35, 1, v2
  v_lshlrev_b32 v35, 4, v35
  v_and_b32 v36, 2, v2
  v_lshl_add_u32 v35, v36, 2, v35
  v_bfe_u32 v36, v2, 4, 1
  v_lshl_add_u32 v35, v36, 5, v35
  v_mul_u32_u24 v37, 192, v34
  v_add3_u32 v14, v37, v35, 0
  v_add_u32 v14, 73728, v14
  v_lshl_add_u32 v37, v34, 7, v35
  v_bfe_u32 v38, v2, 3, 1
  v_lshl_add_u32 v37, v38, 6, v37
  v_xor_b32 v16, 64, v37
  v_mov_b32 v15, v37
  v_lshlrev_b32 v17, 4, v33
  v_add_u32 v17, 143360, v17
  v_mov_b32 v1, 0
  v_mov_b32 v32, 160768
  ds_write_b32 v32, v1
  s_lshl_b32 s68, s2, 2
  s_add_u32 s68, s68, s51
  s_cmp_lt_u32 s68, 896
  s_cselect_b32 s74, 0, 0x04000000
  s_sub_u32 s69, s68, 896
  s_cmp_lt_u32 s68, 896
  s_cselect_b32 s68, s68, s69
  s_cselect_b32 s36, s14, s8
  s_cselect_b32 s37, s15, s9
  s_mov_b32 s38, 524288
  s_cselect_b32 s38, 1835008, s38
  s_cselect_b32 s69, 112, 32
  s_cselect_b32 s77, 3, 2
  s_mov_b32 s76, 16777216
  s_cselect_b32 s76, 14680064, s76
  s_cselect_b32 s79, 9, 10
  s_and_b32 s37, s37, 0xffff
  s_mov_b32 s39, 0x20000
  s_lshr_b32 s70, s68, 3
  s_and_b32 s71, s68, 7
  s_lshl_b32 s72, s70, 14
  s_lshl_b32 s73, s71, 7
  s_add_u32 s72, s72, s73
  s_add_u32 s40, s72, s74
  s_add_u32 s41, s40, 8192
  s_mul_i32 s75, s71, s69
  s_lshl_b32 s75, s75, 1
  s_add_u32 s75, s75, s70
  s_lshl_b32 s75, s75, 10
  s_add_u32 s75, s75, s76
  s_add_u32 s42, s75, s74
  s_lshl_b32 s69, s69, 10
  s_add_u32 s43, s42, s69
  s_lshl_b32 s78, s48, 11
  s_add_u32 s78, s78, 132096
  s_lshl_b32 s79, 1, s79
  v_lshrrev_b32 v120, 3, v2
  v_and_b32 v121, 7, v2
  v_lshlrev_b32 v121, 4, v121
  v_lshl_add_u32 v120, v120, 10, v121
  v_lshrrev_b32 v121, 5, v2
  v_lshlrev_b32 v121, s77, v121
  v_bfe_u32 v40, v2, 2, 2
  v_add_u32 v121, v121, v40
  v_lshlrev_b32 v121, 7, v121
  v_bfe_u32 v40, v2, 4, 1
  v_lshl_add_u32 v121, v40, 5, v121
  v_and_b32 v40, 3, v2
  v_lshl_add_u32 v121, v40, 3, v121
  v_add_u32 v121, s78, v121
  v_add_u32 v122, s79, v121
  s_mov_b32 s76, 0xbfb8aa3b
  s_lshl_b32 s64, s49, 2
  s_add_u32 s64, s64, s51
  s_lshl_b32 s65, s64, 10
  s_mul_i32 s5, s50, 6
  s_lshl_b32 s66, s5, 16
  s_add_u32 s4, s65, s66
  s_lshl_b32 s7, s64, 7
  s_add_u32 s7, s7, 17825792
  s_lshl_b32 s67, s50, 1
  s_add_u32 s67, s67, 0
  s_lshl_b32 s67, s67, 6
  s_add_u32 s67, s67, s64
  s_lshl_b32 s67, s67, 3
  s_add_u32 s6, s67, 24117248
  v_lshlrev_b32 v9, 14, v2
  s_and_b32 s70, s2, 7
  s_lshl_b32 s70, s70, 2
  s_bfe_u32 s71, s2, 0x20003
  s_add_u32 s70, s70, s71
  s_add_u32 s71, s70, 32
  s_mul_i32 s75, s71, 10923
  s_lshr_b32 s75, s75, 16
  s_mul_i32 s68, s75, 6
  s_sub_u32 s71, s71, s68
  s_cmp_lt_u32 s71, 4
  s_addc_u32 s75, s75, s75
  s_lshl_b32 s75, s75, 9
  s_add_u32 s72, s75, 24117248
  s_add_u32 s71, s70, 64
  s_mul_i32 s75, s71, 10923
  s_lshr_b32 s75, s75, 16
  s_mul_i32 s68, s75, 6
  s_sub_u32 s71, s71, s68
  s_cmp_lt_u32 s71, 4
  s_addc_u32 s75, s75, s75
  s_lshl_b32 s75, s75, 9
  s_add_u32 s73, s75, 24117248
  s_add_u32 s71, s70, 0
  s_mul_i32 s75, s71, 10923
  s_lshr_b32 s75, s75, 16
  s_mul_i32 s68, s75, 6
  s_sub_u32 s71, s71, s68
  s_cmp_lt_u32 s71, 4
  s_addc_u32 s75, s75, s75
  s_lshl_b32 s75, s75, 9
  s_add_u32 s74, s75, 24117248
  s_lshr_b32 s71, s2, 5
  s_lshl_b32 s70, s71, 6
  s_add_u32 s74, s74, s70
  s_and_b32 s71, s71, 7
  s_lshl_b32 s71, s71, 14
  s_add_u32 s72, s72, s71
  s_add_u32 s73, s73, s71
  s_add_u32 s74, s74, s71
  v_lshlrev_b32 v26, 3, v2
  v_and_b32 v27, 63, v26
  v_mov_b32 v28, 0
  v_mov_b32 v29, 0
  s_and_b32 s70, s2, 7
  s_lshl_b32 s70, s70, 2
  s_bfe_u32 s71, s2, 0x20003
  s_add_u32 s53, s70, s71
  s_lshr_b32 s54, s2, 5
  s_lshl_b32 s19, s53, 1
  s_mov_b32 s85, s54
  s_and_b32 s70, s48, 1
  s_lshr_b32 s71, s48, 1
  s_mul_i32 s8, s70, 2097152
  s_lshl_b32 s75, s53, 16
  s_add_u32 s8, s8, s75
  s_lshl_b32 s75, s71, 10
  s_add_u32 s8, s8, s75
  s_add_u32 s8, s8, 2097152
  s_mul_i32 s9, s71, 2064
  s_lshl_b32 s75, s70, 10
  s_add_u32 s9, s9, s75
  s_lshl_b32 s70, s53, 6
  s_add_u32 s70, s70, s51
  s_lshl_b32 s70, s70, 10
  s_add_u32 s10, s70, 2097152
  s_mul_i32 s11, s51, 2064
  s_lshl_b32 s70, s53, 6
  s_lshl_b32 s71, s54, 3
  s_add_u32 s70, s70, s71
  s_lshl_b32 s71, s51, 1
  s_add_u32 s70, s70, s71
  s_lshl_b32 s12, s70, 10
  s_mul_i32 s13, s51, 2064
  v_bfe_u32 v32, v2, 1, 1
  v_lshlrev_b32 v36, 3, v32
  v_add_u32 v36, 2048, v36
  v_lshlrev_b32 v32, 9, v32
  v_bfe_u32 v33, v2, 2, 2
  v_lshl_add_u32 v32, v33, 4, v32
  v_lshrrev_b32 v33, 5, v2
  v_lshl_add_u32 v32, v33, 7, v32
  v_and_b32 v33, 1, v2
  v_lshl_add_u32 v32, v33, 3, v32
  v_and_b32 v33, 16, v2
  v_cmp_eq_u32 vcc, 0, v33
  v_add_u32 v37, 1024, v32
  v_add_u32 v38, 1088, v32
  v_add_u32 v39, 1280, v32
  v_add_u32 v40, 1344, v32
  v_cndmask_b32 v96, v36, v37, vcc
  v_cndmask_b32 v97, v36, v38, vcc
  v_cndmask_b32 v98, v36, v39, vcc
  v_cndmask_b32 v99, v36, v40, vcc
  s_add_u32 s70, s9, 115584
  v_add_u32 v123, s70, v3
  v_mul_u32_u24 v8, 2064, v2
  v_add_u32 v8, 2048, v8
  v_mov_b32 v116, 0x3f80
  v_mov_b32 v117, 0
  v_mov_b32 v118, 0
  v_mov_b32 v119, 0
  s_and_b32 s71, s48, 1
  s_add_u32 s19, s19, s71
  s_lshr_b32 s3, s48, 1
  s_lshl_b32 s18, s19, 7
  s_add_u32 s18, s18, 17825792
  s_lshl_b32 s17, s54, 3
  s_add_u32 s17, s17, s48
  s_lshl_b32 s17, s17, 7
  s_add_u32 s17, s17, 17825792
  s_mul_i32 s71, s3, 28
  s_mul_i32 s70, s19, 112
  s_add_u32 s70, s70, s71
  s_lshl_b32 s70, s70, 10
  s_add_u32 s15, s70, 6291456
  s_mul_i32 s70, s85, 224
  s_add_u32 s70, s70, s71
  s_lshl_b32 s70, s70, 10
  s_add_u32 s14, s70, 14680064
  s_add_u32 s16, s14, 114688
  s_lshl_b32 s70, s3, 3
  s_lshl_b32 s71, s85, 6
  s_add_u32 s71, s71, s70
  s_lshl_b32 s71, s71, 10
  s_add_u32 s98, s71, 16777216
  s_add_u32 s99, s98, 32768
  s_cmp_ge_u32 s48, 4
  s_cselect_b64 s[96:97], -1, 0
  s_add_u32 s58, s52, 1
  s_and_b32 s58, s58, 7
  s_lshl_b32 s58, s58, 7
  s_add_u32 s58, s58, s55
  s_add_u32 m0, s56, 86016
  s_add_u32 s57, s58, 0
  buffer_load_dwordx4 v4, s[20:23], s57 offen lds
  s_add_u32 m0, s56, 87040
  s_add_u32 s57, s58, 8192
  buffer_load_dwordx4 v5, s[20:23], s57 offen lds
  s_add_u32 m0, s56, 88064
  s_add_u32 s57, s58, 16384
  buffer_load_dwordx4 v4, s[20:23], s57 offen lds
  s_add_u32 m0, s56, 89088
  s_add_u32 s57, s58, 24576
  buffer_load_dwordx4 v5, s[20:23], s57 offen lds
  s_add_u32 s58, s52, 2
  s_and_b32 s58, s58, 7
  s_lshl_b32 s58, s58, 7
  s_add_u32 s58, s58, s55
  s_add_u32 m0, s56, 114688
  s_add_u32 s57, s58, 0
  buffer_load_dwordx4 v4, s[20:23], s57 offen lds
  s_add_u32 m0, s56, 115712
  s_add_u32 s57, s58, 8192
  buffer_load_dwordx4 v5, s[20:23], s57 offen lds
  s_add_u32 m0, s56, 116736
  s_add_u32 s57, s58, 16384
  buffer_load_dwordx4 v4, s[20:23], s57 offen lds
  s_add_u32 m0, s56, 117760
  s_add_u32 s57, s58, 24576
  buffer_load_dwordx4 v5, s[20:23], s57 offen lds
  s_waitcnt vmcnt(8)
  s_waitcnt lgkmcnt(0)
  s_barrier
  s_cmp_eq_u32 s50, 99
  s_cselect_b64 vcc, -1, 0
  ds_read_b128 v[124:127], v10 offset:0
  ds_read_b64_tr_b16 v[44:45], v14 offset:128
  ds_read_b64_tr_b16 v[46:47], v14 offset:896
  ds_read_b128 v[128:131], v11 offset:0
  ds_read_b64_tr_b16 v[48:49], v14 offset:3200
  ds_read_b64_tr_b16 v[50:51], v14 offset:3968
  ds_read_b128 v[132:135], v12 offset:0
  ds_read_b64_tr_b16 v[52:53], v14 offset:6272
  ds_read_b64_tr_b16 v[54:55], v14 offset:7040
  ds_read_b128 v[136:139], v13 offset:0
  ds_read_b64_tr_b16 v[56:57], v14 offset:9344
  ds_read_b64_tr_b16 v[58:59], v14 offset:10112
  s_waitcnt lgkmcnt(9)
  v_mfma_f32_32x32x16_bf16 v[64:79], v[44:47], v[124:127], 0
  s_add_u32 s58, s52, 3
  s_and_b32 s58, s58, 7
  s_lshl_b32 s58, s58, 7
  s_add_u32 s58, s58, s55
  s_add_u32 m0, s56, 0
  s_add_u32 s57, s58, 0
  buffer_load_dwordx4 v4, s[20:23], s57 offen lds
  s_add_u32 m0, s56, 1024
  s_add_u32 s57, s58, 8192
  buffer_load_dwordx4 v5, s[20:23], s57 offen lds
  s_waitcnt lgkmcnt(6)
  v_mfma_f32_32x32x16_bf16 v[64:79], v[48:51], v[128:131], v[64:79]
  s_waitcnt vmcnt(6)
  s_barrier
  ds_read_b128 v[140:143], v10 offset:28672
  ds_read_b64_tr_b16 v[60:61], v14 offset:28800
  ds_read_b64_tr_b16 v[62:63], v14 offset:29568
  ds_read_b128 v[144:147], v11 offset:28672
  ds_read_b64_tr_b16 v[252:253], v14 offset:31872
  ds_read_b64_tr_b16 v[254:255], v14 offset:32640
  s_add_u32 m0, s56, 2048
  s_add_u32 s57, s58, 16384
  buffer_load_dwordx4 v4, s[20:23], s57 offen lds
  s_add_u32 m0, s56, 3072
  s_add_u32 s57, s58, 24576
  buffer_load_dwordx4 v5, s[20:23], s57 offen lds
  s_waitcnt lgkmcnt(9)
  v_mfma_f32_32x32x16_bf16 v[64:79], v[52:55], v[132:135], v[64:79]
  ds_read_b128 v[148:151], v12 offset:28672
  ds_read_b64_tr_b16 v[44:45], v14 offset:34944
  ds_read_b64_tr_b16 v[46:47], v14 offset:35712
  s_add_u32 s58, s52, 4
  s_and_b32 s58, s58, 7
  s_lshl_b32 s58, s58, 7
  s_add_u32 s58, s58, s55
  s_add_u32 m0, s56, 28672
  s_add_u32 s57, s58, 0
  buffer_load_dwordx4 v4, s[20:23], s57 offen lds
  s_add_u32 m0, s56, 29696
  s_add_u32 s57, s58, 8192
  buffer_load_dwordx4 v5, s[20:23], s57 offen lds
  s_waitcnt lgkmcnt(9)
  v_mfma_f32_32x32x16_bf16 v[64:79], v[56:59], v[136:139], v[64:79]
  ds_read_b128 v[152:155], v13 offset:28672
  ds_read_b64_tr_b16 v[48:49], v14 offset:38016
  ds_read_b64_tr_b16 v[50:51], v14 offset:38784
  s_add_u32 m0, s56, 30720
  s_add_u32 s57, s58, 16384
  buffer_load_dwordx4 v4, s[20:23], s57 offen lds
  s_add_u32 m0, s56, 31744
  s_add_u32 s57, s58, 24576
  buffer_load_dwordx4 v5, s[20:23], s57 offen lds
  s_waitcnt lgkmcnt(9)
  v_mfma_f32_32x32x16_bf16 v[64:79], v[60:63], v[140:143], v[64:79]
  s_waitcnt lgkmcnt(6)
  v_mfma_f32_32x32x16_bf16 v[64:79], v[252:255], v[144:147], v[64:79]
  s_waitcnt vmcnt(8)
  s_barrier
  v_add_u32 v10, 57344, v10
  v_add_u32 v11, 57344, v11
  v_add_u32 v12, 57344, v12
  v_add_u32 v13, 57344, v13
  v_add_u32 v14, 57344, v14
  ds_read_b128 v[156:159], v10 offset:0
  ds_read_b64_tr_b16 v[52:53], v14 offset:128
  ds_read_b64_tr_b16 v[54:55], v14 offset:896
  ds_read_b128 v[160:163], v11 offset:0
  ds_read_b64_tr_b16 v[56:57], v14 offset:3200
  ds_read_b64_tr_b16 v[58:59], v14 offset:3968
  s_add_u32 s58, s52, 5
  s_and_b32 s58, s58, 7
  s_lshl_b32 s58, s58, 7
  s_add_u32 s58, s58, s55
  s_add_u32 m0, s56, 57344
  s_add_u32 s57, s58, 0
  buffer_load_dwordx4 v4, s[20:23], s57 offen lds
  s_add_u32 m0, s56, 58368
  s_add_u32 s57, s58, 8192
  buffer_load_dwordx4 v5, s[20:23], s57 offen lds
  s_waitcnt lgkmcnt(9)
  v_mfma_f32_32x32x16_bf16 v[64:79], v[44:47], v[148:151], v[64:79]
  ds_read_b128 v[164:167], v12 offset:0
  ds_read_b64_tr_b16 v[60:61], v14 offset:6272
  ds_read_b64_tr_b16 v[62:63], v14 offset:7040
  s_add_u32 m0, s56, 59392
  s_add_u32 s57, s58, 16384
  buffer_load_dwordx4 v4, s[20:23], s57 offen lds
  s_add_u32 m0, s56, 60416
  s_add_u32 s57, s58, 24576
  buffer_load_dwordx4 v5, s[20:23], s57 offen lds
  s_waitcnt lgkmcnt(9)
  v_mfma_f32_32x32x16_bf16 v[64:79], v[48:51], v[152:155], v[64:79]
  ds_read_b128 v[168:171], v13 offset:0
  ds_read_b64_tr_b16 v[252:253], v14 offset:9344
  ds_read_b64_tr_b16 v[254:255], v14 offset:10112
  s_waitcnt lgkmcnt(9)
  v_mfma_f32_32x32x16_bf16 v[64:79], v[52:55], v[156:159], v[64:79]
  s_waitcnt lgkmcnt(6)
  v_mfma_f32_32x32x16_bf16 v[64:79], v[56:59], v[160:163], v[64:79]
  s_waitcnt vmcnt(8)
  s_barrier
  v_add_u32 v10, 4294852608, v10
  v_add_u32 v11, 4294852608, v11
  v_add_u32 v12, 4294852608, v12
  v_add_u32 v13, 4294852608, v13
  v_add_u32 v14, 4294852608, v14
  ds_read_b128 v[172:175], v10 offset:0
  ds_read_b64_tr_b16 v[44:45], v14 offset:128
  ds_read_b64_tr_b16 v[46:47], v14 offset:896
  ds_read_b128 v[176:179], v11 offset:0
  ds_read_b64_tr_b16 v[48:49], v14 offset:3200
  ds_read_b64_tr_b16 v[50:51], v14 offset:3968
  s_add_u32 s58, s52, 6
  s_and_b32 s58, s58, 7
  s_lshl_b32 s58, s58, 7
  s_add_u32 s58, s58, s55
  s_add_u32 m0, s56, 86016
  s_add_u32 s57, s58, 0
  buffer_load_dwordx4 v4, s[20:23], s57 offen lds
  s_add_u32 m0, s56, 87040
  s_add_u32 s57, s58, 8192
  buffer_load_dwordx4 v5, s[20:23], s57 offen lds
  s_waitcnt lgkmcnt(9)
  v_mfma_f32_32x32x16_bf16 v[64:79], v[60:63], v[164:167], v[64:79]
  ds_read_b128 v[180:183], v12 offset:0
  ds_read_b64_tr_b16 v[52:53], v14 offset:6272
  ds_read_b64_tr_b16 v[54:55], v14 offset:7040
  s_add_u32 m0, s56, 88064
  s_add_u32 s57, s58, 16384
  buffer_load_dwordx4 v4, s[20:23], s57 offen lds
  s_add_u32 m0, s56, 89088
  s_add_u32 s57, s58, 24576
  buffer_load_dwordx4 v5, s[20:23], s57 offen lds
  s_waitcnt lgkmcnt(9)
  v_mfma_f32_32x32x16_bf16 v[64:79], v[252:255], v[168:171], v[64:79]
  ds_read_b128 v[184:187], v13 offset:0
  ds_read_b64_tr_b16 v[56:57], v14 offset:9344
  ds_read_b64_tr_b16 v[58:59], v14 offset:10112
  s_waitcnt lgkmcnt(9)
  v_mfma_f32_32x32x16_bf16 v[64:79], v[44:47], v[172:175], v[64:79]
  s_waitcnt lgkmcnt(6)
  v_mfma_f32_32x32x16_bf16 v[64:79], v[48:51], v[176:179], v[64:79]
  s_waitcnt vmcnt(8)
  s_barrier
  ds_read_b128 v[188:191], v10 offset:28672
  ds_read_b64_tr_b16 v[60:61], v14 offset:28800
  ds_read_b64_tr_b16 v[62:63], v14 offset:29568
  ds_read_b128 v[192:195], v11 offset:28672
  ds_read_b64_tr_b16 v[252:253], v14 offset:31872
  ds_read_b64_tr_b16 v[254:255], v14 offset:32640
  s_add_u32 s58, s52, 7
  s_and_b32 s58, s58, 7
  s_lshl_b32 s58, s58, 7
  s_add_u32 s58, s58, s55
  s_add_u32 m0, s56, 114688
  s_add_u32 s57, s58, 0
  buffer_load_dwordx4 v4, s[20:23], s57 offen lds
  s_add_u32 m0, s56, 115712
  s_add_u32 s57, s58, 8192
  buffer_load_dwordx4 v5, s[20:23], s57 offen lds
  s_waitcnt lgkmcnt(9)
  v_mfma_f32_32x32x16_bf16 v[64:79], v[52:55], v[180:183], v[64:79]
  ds_read_b128 v[196:199], v12 offset:28672
  ds_read_b64_tr_b16 v[44:45], v14 offset:34944
  ds_read_b64_tr_b16 v[46:47], v14 offset:35712
  s_add_u32 m0, s56, 116736
  s_add_u32 s57, s58, 16384
  buffer_load_dwordx4 v4, s[20:23], s57 offen lds
  s_add_u32 m0, s56, 117760
  s_add_u32 s57, s58, 24576
  buffer_load_dwordx4 v5, s[20:23], s57 offen lds
  s_waitcnt lgkmcnt(9)
  v_mfma_f32_32x32x16_bf16 v[64:79], v[56:59], v[184:187], v[64:79]
  ds_read_b128 v[200:203], v13 offset:28672
  ds_read_b64_tr_b16 v[48:49], v14 offset:38016
  ds_read_b64_tr_b16 v[50:51], v14 offset:38784
  s_waitcnt lgkmcnt(9)
  v_mfma_f32_32x32x16_bf16 v[64:79], v[60:63], v[188:191], v[64:79]
  s_waitcnt lgkmcnt(6)
  v_mfma_f32_32x32x16_bf16 v[64:79], v[252:255], v[192:195], v[64:79]
  s_waitcnt vmcnt(8)
  s_barrier
  v_add_u32 v10, 57344, v10
  v_add_u32 v11, 57344, v11
  v_add_u32 v12, 57344, v12
  v_add_u32 v13, 57344, v13
  v_add_u32 v14, 57344, v14
  ds_read_b128 v[204:207], v10 offset:0
  ds_read_b64_tr_b16 v[52:53], v14 offset:128
  ds_read_b64_tr_b16 v[54:55], v14 offset:896
  ds_read_b128 v[208:211], v11 offset:0
  ds_read_b64_tr_b16 v[56:57], v14 offset:3200
  ds_read_b64_tr_b16 v[58:59], v14 offset:3968
  s_add_u32 s58, s62, 0
  s_and_b32 s58, s58, 15
  s_mul_i32 s58, s58, 114688
  s_add_u32 s58, s58, s59
  s_add_u32 m0, s60, 0
  s_nop 0
  buffer_load_dwordx4 v7, s[28:31], s58 offen lds
  s_add_u32 s58, s62, 1
  s_and_b32 s58, s58, 15
  s_mul_i32 s58, s58, 114688
  s_add_u32 s58, s58, s59
  s_add_u32 m0, s60, 4096
  s_nop 0
  buffer_load_dwordx4 v7, s[28:31], s58 offen lds
  s_waitcnt lgkmcnt(9)
  v_mfma_f32_32x32x16_bf16 v[64:79], v[44:47], v[196:199], v[64:79]
  ds_read_b128 v[212:215], v12 offset:0
  ds_read_b64_tr_b16 v[60:61], v14 offset:6272
  ds_read_b64_tr_b16 v[62:63], v14 offset:7040
  s_add_u32 s58, s62, 2
  s_and_b32 s58, s58, 15
  s_mul_i32 s58, s58, 114688
  s_add_u32 s58, s58, s59
  s_add_u32 m0, s60, 8192
  s_nop 0
  buffer_load_dwordx4 v7, s[28:31], s58 offen lds
  s_add_u32 s58, s62, 3
  s_and_b32 s58, s58, 15
  s_mul_i32 s58, s58, 114688
  s_add_u32 s58, s58, s59
  s_add_u32 m0, s60, 12288
  s_nop 0
  buffer_load_dwordx4 v7, s[28:31], s58 offen lds
  s_waitcnt lgkmcnt(9)
  v_mfma_f32_32x32x16_bf16 v[64:79], v[48:51], v[200:203], v[64:79]
  ds_read_b128 v[216:219], v13 offset:0
  ds_read_b64_tr_b16 v[252:253], v14 offset:9344
  ds_read_b64_tr_b16 v[254:255], v14 offset:10112
  s_add_u32 s58, s62, 4
  s_and_b32 s58, s58, 15
  s_mul_i32 s58, s58, 114688
  s_add_u32 s58, s58, s59
  s_add_u32 m0, s60, 16384
  s_nop 0
  buffer_load_dwordx4 v7, s[28:31], s58 offen lds
  s_add_u32 s58, s62, 5
  s_and_b32 s58, s58, 15
  s_mul_i32 s58, s58, 114688
  s_add_u32 s58, s58, s59
  s_add_u32 m0, s60, 20480
  s_nop 0
  buffer_load_dwordx4 v7, s[28:31], s58 offen lds
  s_waitcnt lgkmcnt(9)
  v_mfma_f32_32x32x16_bf16 v[64:79], v[52:55], v[204:207], v[64:79]
  s_add_u32 s58, s62, 6
  s_and_b32 s58, s58, 15
  s_mul_i32 s58, s58, 114688
  s_add_u32 s58, s58, s59
  s_add_u32 m0, s60, 24576
  s_nop 0
  buffer_load_dwordx4 v7, s[28:31], s58 offen lds
  buffer_load_dwordx2 v[30:31], v1, s[80:83], 0 offen sc0 sc1
  s_waitcnt lgkmcnt(6)
  v_mfma_f32_32x32x16_bf16 v[64:79], v[56:59], v[208:211], v[64:79]
  s_waitcnt vmcnt(12)
  s_barrier
  ds_read_b128 v[220:223], v10 offset:28672
  ds_read_b64_tr_b16 v[44:45], v14 offset:28800
  ds_read_b64_tr_b16 v[46:47], v14 offset:29568
  ds_read_b128 v[224:227], v11 offset:28672
  ds_read_b64_tr_b16 v[48:49], v14 offset:31872
  ds_read_b64_tr_b16 v[50:51], v14 offset:32640
  s_add_u32 s58, s62, 7
  s_and_b32 s58, s58, 15
  s_mul_i32 s58, s58, 114688
  s_add_u32 s58, s58, s59
  s_add_u32 m0, s60, 28672
  s_nop 0
  buffer_load_dwordx4 v7, s[28:31], s58 offen lds
  s_add_u32 s58, s62, 8
  s_and_b32 s58, s58, 15
  s_mul_i32 s58, s58, 114688
  s_add_u32 s58, s58, s59
  s_add_u32 m0, s60, 32768
  s_nop 0
  buffer_load_dwordx4 v7, s[28:31], s58 offen lds
  s_waitcnt lgkmcnt(9)
  v_mfma_f32_32x32x16_bf16 v[64:79], v[60:63], v[212:215], v[64:79]
  ds_read_b128 v[228:231], v12 offset:28672
  ds_read_b64_tr_b16 v[52:53], v14 offset:34944
  ds_read_b64_tr_b16 v[54:55], v14 offset:35712
  s_add_u32 s58, s62, 9
  s_and_b32 s58, s58, 15
  s_mul_i32 s58, s58, 114688
  s_add_u32 s58, s58, s59
  s_add_u32 m0, s60, 36864
  s_nop 0
  buffer_load_dwordx4 v7, s[28:31], s58 offen lds
  s_add_u32 s58, s62, 10
  s_and_b32 s58, s58, 15
  s_mul_i32 s58, s58, 114688
  s_add_u32 s58, s58, s59
  s_add_u32 m0, s60, 40960
  s_nop 0
  buffer_load_dwordx4 v7, s[28:31], s58 offen lds
  s_waitcnt lgkmcnt(9)
  v_mfma_f32_32x32x16_bf16 v[64:79], v[252:255], v[216:219], v[64:79]
  ds_read_b128 v[232:235], v13 offset:28672
  ds_read_b64_tr_b16 v[56:57], v14 offset:38016
  ds_read_b64_tr_b16 v[58:59], v14 offset:38784
  s_add_u32 s58, s62, 11
  s_and_b32 s58, s58, 15
  s_mul_i32 s58, s58, 114688
  s_add_u32 s58, s58, s59
  s_add_u32 m0, s60, 45056
  s_nop 0
  buffer_load_dwordx4 v7, s[28:31], s58 offen lds
  s_add_u32 s58, s62, 12
  s_and_b32 s58, s58, 15
  s_mul_i32 s58, s58, 114688
  s_add_u32 s58, s58, s59
  s_add_u32 m0, s60, 49152
  s_nop 0
  buffer_load_dwordx4 v7, s[28:31], s58 offen lds
  s_waitcnt lgkmcnt(9)
  v_mfma_f32_32x32x16_bf16 v[64:79], v[44:47], v[220:223], v[64:79]
  s_add_u32 s58, s62, 13
  s_and_b32 s58, s58, 15
  s_mul_i32 s58, s58, 114688
  s_add_u32 s58, s58, s59
  s_add_u32 m0, s60, 53248
  s_nop 0
  buffer_load_dwordx4 v7, s[28:31], s58 offen lds
  s_waitcnt lgkmcnt(6)
  v_mfma_f32_32x32x16_bf16 v[64:79], v[48:51], v[224:227], v[64:79]
  s_waitcnt vmcnt(15)
  s_waitcnt lgkmcnt(0)
  s_barrier
  v_add_u32 v10, 57344, v10
  v_add_u32 v11, 57344, v11
  v_add_u32 v12, 57344, v12
  v_add_u32 v13, 57344, v13
  v_add_u32 v14, 57344, v14
  ds_read_b128 v[236:239], v10 offset:0
  ds_read_b64_tr_b16 v[60:61], v14 offset:128
  ds_read_b64_tr_b16 v[62:63], v14 offset:896
  ds_read_b128 v[240:243], v11 offset:0
  ds_read_b64_tr_b16 v[252:253], v14 offset:3200
  ds_read_b64_tr_b16 v[254:255], v14 offset:3968
  s_add_u32 s58, s62, 14
  s_and_b32 s58, s58, 15
  s_mul_i32 s58, s58, 114688
  s_add_u32 s58, s58, s59
  s_add_u32 m0, s60, 57344
  s_nop 0
  buffer_load_dwordx4 v7, s[28:31], s58 offen lds
  s_add_u32 s58, s62, 15
  s_and_b32 s58, s58, 15
  s_mul_i32 s58, s58, 114688
  s_add_u32 s58, s58, s59
  s_add_u32 m0, s60, 61440
  s_nop 0
  buffer_load_dwordx4 v7, s[28:31], s58 offen lds
  v_mfma_f32_32x32x16_bf16 v[64:79], v[52:55], v[228:231], v[64:79]
  ds_read_b128 v[244:247], v12 offset:0
  ds_read_b64_tr_b16 v[44:45], v14 offset:6272
  ds_read_b64_tr_b16 v[46:47], v14 offset:7040
  s_add_u32 s58, s62, 0
  s_and_b32 s58, s58, 15
  s_mul_i32 s58, s58, 114688
  s_add_u32 s58, s58, s59
  s_add_u32 s58, s58, s100
  s_add_u32 m0, s60, 65536
  s_nop 0
  buffer_load_dwordx4 v7, s[28:31], s58 offen lds
  s_add_u32 s58, s62, 1
  s_and_b32 s58, s58, 15
  s_mul_i32 s58, s58, 114688
  s_add_u32 s58, s58, s59
  s_add_u32 s58, s58, s100
  s_add_u32 m0, s60, 69632
  s_nop 0
  buffer_load_dwordx4 v7, s[28:31], s58 offen lds
  v_mfma_f32_32x32x16_bf16 v[64:79], v[56:59], v[232:235], v[64:79]
  ds_read_b128 v[248:251], v13 offset:0
  ds_read_b64_tr_b16 v[48:49], v14 offset:9344
  ds_read_b64_tr_b16 v[50:51], v14 offset:10112
  s_add_u32 s58, s62, 2
  s_and_b32 s58, s58, 15
  s_mul_i32 s58, s58, 114688
  s_add_u32 s58, s58, s59
  s_add_u32 s58, s58, s100
  s_add_u32 m0, s60, 73728
  s_nop 0
  buffer_load_dwordx4 v7, s[28:31], s58 offen lds
  s_add_u32 s58, s62, 3
  s_and_b32 s58, s58, 15
  s_mul_i32 s58, s58, 114688
  s_add_u32 s58, s58, s59
  s_add_u32 s58, s58, s100
  s_add_u32 m0, s60, 77824
  s_nop 0
  buffer_load_dwordx4 v7, s[28:31], s58 offen lds
  s_waitcnt lgkmcnt(9)
  v_mfma_f32_32x32x16_bf16 v[64:79], v[60:63], v[236:239], v[64:79]
  s_add_u32 s58, s62, 4
  s_and_b32 s58, s58, 15
  s_mul_i32 s58, s58, 114688
  s_add_u32 s58, s58, s59
  s_add_u32 s58, s58, s100
  s_add_u32 m0, s60, 81920
  s_nop 0
  buffer_load_dwordx4 v7, s[28:31], s58 offen lds
  s_add_u32 s58, s62, 12
  s_and_b32 s58, s58, 15
  s_mul_i32 s58, s58, 114688
  s_add_u32 s58, s58, s59
  s_add_u32 s58, s58, s100
  s_add_u32 m0, s60, 144384
  s_nop 0
  buffer_load_dwordx4 v7, s[28:31], s58 offen lds
  s_waitcnt lgkmcnt(6)
  v_mfma_f32_32x32x16_bf16 v[64:79], v[252:255], v[240:243], v[64:79]
  s_waitcnt vmcnt(16)
  s_barrier
  ds_read_b64_tr_b16 v[52:53], v15 offset:0
  ds_read_b64_tr_b16 v[54:55], v15 offset:512
  ds_read_b64_tr_b16 v[56:57], v16 offset:0
  ds_read_b64_tr_b16 v[58:59], v16 offset:512
  ds_read_b64_tr_b16 v[60:61], v15 offset:2048
  ds_read_b64_tr_b16 v[62:63], v15 offset:2560
  ds_read_b64_tr_b16 v[252:253], v16 offset:2048
  ds_read_b64_tr_b16 v[254:255], v16 offset:2560
  s_add_u32 s58, s62, 13
  s_and_b32 s58, s58, 15
  s_mul_i32 s58, s58, 114688
  s_add_u32 s58, s58, s59
  s_add_u32 s58, s58, s100
  s_add_u32 m0, s60, 148480
  s_nop 0
  buffer_load_dwordx4 v7, s[28:31], s58 offen lds
  s_add_u32 s58, s62, 14
  s_and_b32 s58, s58, 15
  s_mul_i32 s58, s58, 114688
  s_add_u32 s58, s58, s59
  s_add_u32 s58, s58, s100
  s_add_u32 m0, s60, 152576
  s_nop 0
  buffer_load_dwordx4 v7, s[28:31], s58 offen lds
  s_waitcnt lgkmcnt(11)
  v_mfma_f32_32x32x16_bf16 v[64:79], v[44:47], v[244:247], v[64:79]
  ds_read_b64_tr_b16 v[44:45], v15 offset:4096
  ds_read_b64_tr_b16 v[46:47], v15 offset:4608
  s_add_u32 s58, s62, 15
  s_and_b32 s58, s58, 15
  s_mul_i32 s58, s58, 114688
  s_add_u32 s58, s58, s59
  s_add_u32 s58, s58, s100
  s_add_u32 m0, s60, 156672
  s_nop 0
  buffer_load_dwordx4 v7, s[28:31], s58 offen lds
  s_add_u32 s58, s62, 5
  s_and_b32 s58, s58, 15
  s_mul_i32 s58, s58, 114688
  s_add_u32 s58, s58, s59
  s_add_u32 s58, s58, s100
  s_add_u32 m0, s60, 86016
  s_nop 0
  buffer_load_dwordx4 v7, s[28:31], s58 offen lds
  s_waitcnt lgkmcnt(10)
  v_mfma_f32_32x32x16_bf16 v[64:79], v[48:51], v[248:251], v[64:79]
  ds_read_b64_tr_b16 v[48:49], v16 offset:4096
  ds_read_b64_tr_b16 v[50:51], v16 offset:4608
  s_add_u32 s58, s62, 6
  s_and_b32 s58, s58, 15
  s_mul_i32 s58, s58, 114688
  s_add_u32 s58, s58, s59
  s_add_u32 s58, s58, s100
  s_add_u32 m0, s60, 90112
  s_nop 0
  buffer_load_dwordx4 v7, s[28:31], s58 offen lds
  s_add_u32 s58, s62, 7
  s_and_b32 s58, s58, 15
  s_mul_i32 s58, s58, 114688
  s_add_u32 s58, s58, s59
  s_add_u32 s58, s58, s100
  s_add_u32 m0, s60, 94208
  s_nop 0
  buffer_load_dwordx4 v7, s[28:31], s58 offen lds
  s_add_u32 s58, s62, 8
  s_and_b32 s58, s58, 15
  s_mul_i32 s58, s58, 114688
  s_add_u32 s58, s58, s59
  s_add_u32 s58, s58, s100
  s_add_u32 m0, s60, 98304
  s_nop 0
  buffer_load_dwordx4 v7, s[28:31], s58 offen lds
  s_add_u32 s58, s62, 9
  s_and_b32 s58, s58, 15
  s_mul_i32 s58, s58, 114688
  s_add_u32 s58, s58, s59
  s_add_u32 s58, s58, s100
  s_add_u32 m0, s60, 102400
  s_nop 0
  buffer_load_dwordx4 v7, s[28:31], s58 offen lds
  s_add_u32 s58, s62, 10
  s_and_b32 s58, s58, 15
  s_mul_i32 s58, s58, 114688
  s_add_u32 s58, s58, s59
  s_add_u32 s58, s58, s100
  s_add_u32 m0, s60, 106496
  s_nop 0
  buffer_load_dwordx4 v7, s[28:31], s58 offen lds
  s_add_u32 s58, s62, 11
  s_and_b32 s58, s58, 15
  s_mul_i32 s58, s58, 114688
  s_add_u32 s58, s58, s59
  s_add_u32 s58, s58, s100
  s_add_u32 m0, s60, 110592
  s_nop 0
  buffer_load_dwordx4 v7, s[28:31], s58 offen lds
  s_setprio 2
  s_waitcnt lgkmcnt(10)
  v_mfma_f32_32x32x16_bf16 v[80:95], v[52:55], v[124:127], 0
  ds_read_b64_tr_b16 v[52:53], v15 offset:6144
  ds_read_b64_tr_b16 v[54:55], v15 offset:6656
  s_nop 8
  s_cmp_lt_u32 s5, 28
  s_cselect_b32 s66, 0x3eb8aa3b, 1.0
  s_cbranch_scc0 F_nq0_4
  v_mul_f32 v64, s66, v64
  v_mul_f32 v65, s66, v65
  v_mul_f32 v66, s66, v66
  v_mul_f32 v67, s66, v67
  v_mul_f32 v68, s66, v68
  v_mul_f32 v69, s66, v69
  v_mul_f32 v70, s66, v70
  v_mul_f32 v71, s66, v71
F_nq0_4:
  s_waitcnt lgkmcnt(10)
  v_mfma_f32_32x32x16_bf16 v[100:115], v[56:59], v[124:127], 0
  ds_read_b64_tr_b16 v[56:57], v16 offset:6144
  ds_read_b64_tr_b16 v[58:59], v16 offset:6656
  s_add_u32 s67, s4, 262144
  v_cvt_pk_bf16_f32 v32, v64, v65
  v_cvt_pk_bf16_f32 v33, v66, v67
  v_cvt_pk_bf16_f32 v34, v68, v69
  v_cvt_pk_bf16_f32 v35, v70, v71
  buffer_store_dwordx4 v[32:35], v3, s[32:35], s67 offen sc1
  s_waitcnt lgkmcnt(10)
  v_mfma_f32_32x32x16_bf16 v[80:95], v[60:63], v[128:131], v[80:95]
  ds_read_b64_tr_b16 v[60:61], v15 offset:8192
  ds_read_b64_tr_b16 v[62:63], v15 offset:8704
  s_cmp_lt_u32 s5, 27
  s_cselect_b32 s66, 0x3eb8aa3b, 1.0
  s_cbranch_scc0 F_nq0_5
  v_mul_f32 v72, s66, v72
  v_mul_f32 v73, s66, v73
  v_mul_f32 v74, s66, v74
  v_mul_f32 v75, s66, v75
  v_mul_f32 v76, s66, v76
  v_mul_f32 v77, s66, v77
  v_mul_f32 v78, s66, v78
  v_mul_f32 v79, s66, v79
F_nq0_5:
  s_waitcnt lgkmcnt(10)
  v_mfma_f32_32x32x16_bf16 v[100:115], v[252:255], v[128:131], v[100:115]
  ds_read_b64_tr_b16 v[252:253], v16 offset:8192
  ds_read_b64_tr_b16 v[254:255], v16 offset:8704
  s_add_u32 s67, s4, 327680
  v_cvt_pk_bf16_f32 v36, v72, v73
  v_cvt_pk_bf16_f32 v37, v74, v75
  v_cvt_pk_bf16_f32 v38, v76, v77
  v_cvt_pk_bf16_f32 v39, v78, v79
  buffer_store_dwordx4 v[36:39], v3, s[32:35], s67 offen sc1
  s_waitcnt lgkmcnt(10)
  v_mfma_f32_32x32x16_bf16 v[80:95], v[44:47], v[132:135], v[80:95]
  ds_read_b64_tr_b16 v[44:45], v15 offset:10240
  ds_read_b64_tr_b16 v[46:47], v15 offset:10752
  s_waitcnt vmcnt(27)
  v_readfirstlane_b32 s86, v30
  v_readfirstlane_b32 s87, v31
  s_cmp_lg_u32 s87, 0
  s_cbranch_scc1 F_ep0_ok
  s_mov_b32 s79, 32768
F_ep0_retry:
  s_sleep 2
  buffer_load_dwordx2 v[30:31], v1, s[80:83], 0 offen sc0 sc1
  s_waitcnt vmcnt(0)
  v_readfirstlane_b32 s86, v30
  v_readfirstlane_b32 s87, v31
  s_cmp_lg_u32 s87, 0
  s_cbranch_scc1 F_ep0_ok
  s_sub_u32 s79, s79, 1
  s_cmp_lg_u32 s79, 0
  s_cbranch_scc1 F_ep0_retry
F_ep0_ok:
  s_waitcnt lgkmcnt(10)
  v_mfma_f32_32x32x16_bf16 v[100:115], v[48:51], v[132:135], v[100:115]
  ds_read_b64_tr_b16 v[48:49], v16 offset:10240
  ds_read_b64_tr_b16 v[50:51], v16 offset:10752
  s_waitcnt lgkmcnt(10)
  v_mfma_f32_32x32x16_bf16 v[80:95], v[52:55], v[136:139], v[80:95]
  ds_read_b64_tr_b16 v[52:53], v15 offset:12288
  ds_read_b64_tr_b16 v[54:55], v15 offset:12800
  s_waitcnt lgkmcnt(10)
  v_mfma_f32_32x32x16_bf16 v[100:115], v[56:59], v[136:139], v[100:115]
  ds_read_b64_tr_b16 v[56:57], v16 offset:12288
  ds_read_b64_tr_b16 v[58:59], v16 offset:12800
  s_waitcnt lgkmcnt(10)
  v_mfma_f32_32x32x16_bf16 v[80:95], v[60:63], v[140:143], v[80:95]
  ds_read_b64_tr_b16 v[60:61], v15 offset:14336
  ds_read_b64_tr_b16 v[62:63], v15 offset:14848
  s_waitcnt lgkmcnt(10)
  v_mfma_f32_32x32x16_bf16 v[100:115], v[252:255], v[140:143], v[100:115]
  ds_read_b64_tr_b16 v[252:253], v16 offset:14336
  ds_read_b64_tr_b16 v[254:255], v16 offset:14848
  s_waitcnt lgkmcnt(10)
  v_mfma_f32_32x32x16_bf16 v[80:95], v[44:47], v[144:147], v[80:95]
  ds_read_b64_tr_b16 v[44:45], v15 offset:16384
  ds_read_b64_tr_b16 v[46:47], v15 offset:16896
  s_waitcnt lgkmcnt(10)
  v_mfma_f32_32x32x16_bf16 v[100:115], v[48:51], v[144:147], v[100:115]
  ds_read_b64_tr_b16 v[48:49], v16 offset:16384
  ds_read_b64_tr_b16 v[50:51], v16 offset:16896
  s_waitcnt lgkmcnt(10)
  v_mfma_f32_32x32x16_bf16 v[80:95], v[52:55], v[148:151], v[80:95]
  ds_read_b64_tr_b16 v[52:53], v15 offset:18432
  ds_read_b64_tr_b16 v[54:55], v15 offset:18944
  s_waitcnt lgkmcnt(10)
  v_mfma_f32_32x32x16_bf16 v[100:115], v[56:59], v[148:151], v[100:115]
  ds_read_b64_tr_b16 v[56:57], v16 offset:18432
  ds_read_b64_tr_b16 v[58:59], v16 offset:18944
  s_waitcnt lgkmcnt(10)
  v_mfma_f32_32x32x16_bf16 v[80:95], v[60:63], v[152:155], v[80:95]
  ds_read_b64_tr_b16 v[60:61], v15 offset:20480
  ds_read_b64_tr_b16 v[62:63], v15 offset:20992
  s_waitcnt lgkmcnt(10)
  v_mfma_f32_32x32x16_bf16 v[100:115], v[252:255], v[152:155], v[100:115]
  ds_read_b64_tr_b16 v[252:253], v16 offset:20480
  ds_read_b64_tr_b16 v[254:255], v16 offset:20992
  s_waitcnt lgkmcnt(10)
  v_mfma_f32_32x32x16_bf16 v[80:95], v[44:47], v[156:159], v[80:95]
  ds_read_b64_tr_b16 v[44:45], v15 offset:22528
  ds_read_b64_tr_b16 v[46:47], v15 offset:23040
  s_waitcnt lgkmcnt(10)
  v_mfma_f32_32x32x16_bf16 v[100:115], v[48:51], v[156:159], v[100:115]
  ds_read_b64_tr_b16 v[48:49], v16 offset:22528
  ds_read_b64_tr_b16 v[50:51], v16 offset:23040
  s_waitcnt lgkmcnt(10)
  v_mfma_f32_32x32x16_bf16 v[80:95], v[52:55], v[160:163], v[80:95]
  ds_read_b64_tr_b16 v[52:53], v15 offset:24576
  ds_read_b64_tr_b16 v[54:55], v15 offset:25088
  s_waitcnt lgkmcnt(10)
  v_mfma_f32_32x32x16_bf16 v[100:115], v[56:59], v[160:163], v[100:115]
  ds_read_b64_tr_b16 v[56:57], v16 offset:24576
  ds_read_b64_tr_b16 v[58:59], v16 offset:25088
  s_waitcnt lgkmcnt(10)
  v_mfma_f32_32x32x16_bf16 v[80:95], v[60:63], v[164:167], v[80:95]
  ds_read_b64_tr_b16 v[60:61], v15 offset:26624
  ds_read_b64_tr_b16 v[62:63], v15 offset:27136
  s_waitcnt lgkmcnt(10)
  v_mfma_f32_32x32x16_bf16 v[100:115], v[252:255], v[164:167], v[100:115]
  ds_read_b64_tr_b16 v[252:253], v16 offset:26624
  ds_read_b64_tr_b16 v[254:255], v16 offset:27136
  s_waitcnt lgkmcnt(10)
  v_mfma_f32_32x32x16_bf16 v[80:95], v[44:47], v[168:171], v[80:95]
  s_waitcnt lgkmcnt(8)
  v_mfma_f32_32x32x16_bf16 v[100:115], v[48:51], v[168:171], v[100:115]
  s_waitcnt lgkmcnt(6)
  v_mfma_f32_32x32x16_bf16 v[80:95], v[52:55], v[172:175], v[80:95]
  s_mov_b32 s66, 0
  s_getreg_b32 s65, hwreg(HW_REG_IB_STS)
  s_and_b32 s65, s65, 0xc0000f
  s_cmp_gt_u32 s65, 0
  s_cbranch_scc1 F_pb0_1
  s_mov_b64 exec, 255
  buffer_store_dwordx2 v[30:31], v9, s[32:35], s6 offen sc1
  s_mov_b64 exec, -1
  s_mov_b32 s66, 1
F_pb0_1:
  s_waitcnt lgkmcnt(4)
  v_mfma_f32_32x32x16_bf16 v[100:115], v[56:59], v[172:175], v[100:115]
  s_waitcnt lgkmcnt(2)
  v_mfma_f32_32x32x16_bf16 v[80:95], v[60:63], v[176:179], v[80:95]
  s_waitcnt lgkmcnt(0)
  v_mfma_f32_32x32x16_bf16 v[100:115], v[252:255], v[176:179], v[100:115]
  s_waitcnt vmcnt(9)
  s_waitcnt vmcnt(2)
  s_barrier
  ds_read_b64_tr_b16 v[44:45], v15 offset:28672
  ds_read_b64_tr_b16 v[46:47], v15 offset:29184
  ds_read_b64_tr_b16 v[48:49], v16 offset:28672
  ds_read_b64_tr_b16 v[50:51], v16 offset:29184
  ds_read_b64_tr_b16 v[52:53], v15 offset:30720
  ds_read_b64_tr_b16 v[54:55], v15 offset:31232
  ds_read_b64_tr_b16 v[56:57], v16 offset:30720
  ds_read_b64_tr_b16 v[58:59], v16 offset:31232
  ds_read_b64_tr_b16 v[60:61], v15 offset:32768
  ds_read_b64_tr_b16 v[62:63], v15 offset:33280
  ds_read_b64_tr_b16 v[252:253], v16 offset:32768
  ds_read_b64_tr_b16 v[254:255], v16 offset:33280
  s_waitcnt lgkmcnt(10)
  v_mfma_f32_32x32x16_bf16 v[80:95], v[44:47], v[180:183], v[80:95]
  ds_read_b64_tr_b16 v[44:45], v15 offset:34816
  ds_read_b64_tr_b16 v[46:47], v15 offset:35328
  s_cmp_lg_u32 s66, 0
  s_cbranch_scc1 F_pb0_2
  s_getreg_b32 s65, hwreg(HW_REG_IB_STS)
  s_and_b32 s65, s65, 0xc0000f
  s_cmp_gt_u32 s65, 0
  s_cbranch_scc1 F_pb0_2
  s_mov_b64 exec, 255
  buffer_store_dwordx2 v[30:31], v9, s[32:35], s6 offen sc1
  s_mov_b64 exec, -1
  s_mov_b32 s66, 1
F_pb0_2:
  s_waitcnt lgkmcnt(10)
  v_mfma_f32_32x32x16_bf16 v[100:115], v[48:51], v[180:183], v[100:115]
  ds_read_b64_tr_b16 v[48:49], v16 offset:34816
  ds_read_b64_tr_b16 v[50:51], v16 offset:35328
  s_waitcnt lgkmcnt(10)
  v_mfma_f32_32x32x16_bf16 v[80:95], v[52:55], v[184:187], v[80:95]
  ds_read_b64_tr_b16 v[52:53], v15 offset:36864
  ds_read_b64_tr_b16 v[54:55], v15 offset:37376
  s_waitcnt lgkmcnt(10)
  v_mfma_f32_32x32x16_bf16 v[100:115], v[56:59], v[184:187], v[100:115]
  ds_read_b64_tr_b16 v[56:57], v16 offset:36864
  ds_read_b64_tr_b16 v[58:59], v16 offset:37376
  s_waitcnt lgkmcnt(10)
  v_mfma_f32_32x32x16_bf16 v[80:95], v[60:63], v[188:191], v[80:95]
  ds_read_b64_tr_b16 v[60:61], v15 offset:38912
  ds_read_b64_tr_b16 v[62:63], v15 offset:39424
  s_cmp_lg_u32 s66, 0
  s_cbranch_scc1 F_pb0_3
  s_getreg_b32 s65, hwreg(HW_REG_IB_STS)
  s_and_b32 s65, s65, 0xc0000f
  s_cmp_gt_u32 s65, 0
  s_cbranch_scc1 F_pb0_3
  s_mov_b64 exec, 255
  buffer_store_dwordx2 v[30:31], v9, s[32:35], s6 offen sc1
  s_mov_b64 exec, -1
  s_mov_b32 s66, 1
F_pb0_3:
  s_waitcnt lgkmcnt(10)
  v_mfma_f32_32x32x16_bf16 v[100:115], v[252:255], v[188:191], v[100:115]
  ds_read_b64_tr_b16 v[252:253], v16 offset:38912
  ds_read_b64_tr_b16 v[254:255], v16 offset:39424
  s_waitcnt lgkmcnt(10)
  v_mfma_f32_32x32x16_bf16 v[80:95], v[44:47], v[192:195], v[80:95]
  ds_read_b64_tr_b16 v[44:45], v15 offset:40960
  ds_read_b64_tr_b16 v[46:47], v15 offset:41472
  s_waitcnt lgkmcnt(10)
  v_mfma_f32_32x32x16_bf16 v[100:115], v[48:51], v[192:195], v[100:115]
  ds_read_b64_tr_b16 v[48:49], v16 offset:40960
  ds_read_b64_tr_b16 v[50:51], v16 offset:41472
  s_waitcnt lgkmcnt(10)
  v_mfma_f32_32x32x16_bf16 v[80:95], v[52:55], v[196:199], v[80:95]
  ds_read_b64_tr_b16 v[52:53], v15 offset:43008
  ds_read_b64_tr_b16 v[54:55], v15 offset:43520
  s_cmp_lg_u32 s66, 0
  s_cbranch_scc1 F_pb0_4
  s_getreg_b32 s65, hwreg(HW_REG_IB_STS)
  s_and_b32 s65, s65, 0xc0000f
  s_cmp_gt_u32 s65, 0
  s_cbranch_scc1 F_pb0_4
  s_mov_b64 exec, 255
  buffer_store_dwordx2 v[30:31], v9, s[32:35], s6 offen sc1
  s_mov_b64 exec, -1
  s_mov_b32 s66, 1
F_pb0_4:
  s_waitcnt lgkmcnt(10)
  v_mfma_f32_32x32x16_bf16 v[100:115], v[56:59], v[196:199], v[100:115]
  ds_read_b64_tr_b16 v[56:57], v16 offset:43008
  ds_read_b64_tr_b16 v[58:59], v16 offset:43520
  s_waitcnt lgkmcnt(10)
  v_mfma_f32_32x32x16_bf16 v[80:95], v[60:63], v[200:203], v[80:95]
  ds_read_b64_tr_b16 v[60:61], v15 offset:45056
  ds_read_b64_tr_b16 v[62:63], v15 offset:45568
  s_waitcnt lgkmcnt(10)
  v_mfma_f32_32x32x16_bf16 v[100:115], v[252:255], v[200:203], v[100:115]
  ds_read_b64_tr_b16 v[252:253], v16 offset:45056
  ds_read_b64_tr_b16 v[254:255], v16 offset:45568
  s_waitcnt lgkmcnt(10)
  v_mfma_f32_32x32x16_bf16 v[80:95], v[44:47], v[204:207], v[80:95]
  ds_read_b64_tr_b16 v[44:45], v15 offset:47104
  ds_read_b64_tr_b16 v[46:47], v15 offset:47616
  s_cmp_lg_u32 s66, 0
  s_cbranch_scc1 F_pb0_5
  s_waitcnt vmcnt(0)
  s_mov_b64 exec, 255
  buffer_store_dwordx2 v[30:31], v9, s[32:35], s6 offen sc1
  s_mov_b64 exec, -1
  s_mov_b32 s66, 1
F_pb0_5:
  s_waitcnt lgkmcnt(10)
  v_mfma_f32_32x32x16_bf16 v[100:115], v[48:51], v[204:207], v[100:115]
  ds_read_b64_tr_b16 v[48:49], v16 offset:47104
  ds_read_b64_tr_b16 v[50:51], v16 offset:47616
  s_waitcnt lgkmcnt(10)
  v_mfma_f32_32x32x16_bf16 v[80:95], v[52:55], v[208:211], v[80:95]
  ds_read_b64_tr_b16 v[52:53], v15 offset:49152
  ds_read_b64_tr_b16 v[54:55], v15 offset:49664
  s_waitcnt lgkmcnt(10)
  v_mfma_f32_32x32x16_bf16 v[100:115], v[56:59], v[208:211], v[100:115]
  ds_read_b64_tr_b16 v[56:57], v16 offset:49152
  ds_read_b64_tr_b16 v[58:59], v16 offset:49664
  s_waitcnt lgkmcnt(10)
  v_mfma_f32_32x32x16_bf16 v[80:95], v[60:63], v[212:215], v[80:95]
  ds_read_b64_tr_b16 v[60:61], v15 offset:51200
  ds_read_b64_tr_b16 v[62:63], v15 offset:51712
  s_waitcnt lgkmcnt(10)
  v_mfma_f32_32x32x16_bf16 v[100:115], v[252:255], v[212:215], v[100:115]
  ds_read_b64_tr_b16 v[252:253], v16 offset:51200
  ds_read_b64_tr_b16 v[254:255], v16 offset:51712
  s_waitcnt lgkmcnt(10)
  v_mfma_f32_32x32x16_bf16 v[80:95], v[44:47], v[216:219], v[80:95]
  ds_read_b64_tr_b16 v[44:45], v15 offset:53248
  ds_read_b64_tr_b16 v[46:47], v15 offset:53760
  s_waitcnt lgkmcnt(10)
  v_mfma_f32_32x32x16_bf16 v[100:115], v[48:51], v[216:219], v[100:115]
  ds_read_b64_tr_b16 v[48:49], v16 offset:53248
  ds_read_b64_tr_b16 v[50:51], v16 offset:53760
  s_waitcnt lgkmcnt(10)
  v_mfma_f32_32x32x16_bf16 v[80:95], v[52:55], v[220:223], v[80:95]
  ds_read_b64_tr_b16 v[52:53], v15 offset:55296
  ds_read_b64_tr_b16 v[54:55], v15 offset:55808
  s_waitcnt lgkmcnt(10)
  v_mfma_f32_32x32x16_bf16 v[100:115], v[56:59], v[220:223], v[100:115]
  ds_read_b64_tr_b16 v[56:57], v16 offset:55296
  ds_read_b64_tr_b16 v[58:59], v16 offset:55808
  s_waitcnt lgkmcnt(10)
  v_mfma_f32_32x32x16_bf16 v[80:95], v[60:63], v[224:227], v[80:95]
  ds_read_b64_tr_b16 v[60:61], v15 offset:57344
  ds_read_b64_tr_b16 v[62:63], v15 offset:57856
  s_waitcnt lgkmcnt(10)
  v_mfma_f32_32x32x16_bf16 v[100:115], v[252:255], v[224:227], v[100:115]
  ds_read_b64_tr_b16 v[252:253], v16 offset:57344
  ds_read_b64_tr_b16 v[254:255], v16 offset:57856
  s_waitcnt lgkmcnt(10)
  v_mfma_f32_32x32x16_bf16 v[80:95], v[44:47], v[228:231], v[80:95]
  ds_read_b64_tr_b16 v[44:45], v15 offset:59392
  ds_read_b64_tr_b16 v[46:47], v15 offset:59904
  s_waitcnt lgkmcnt(10)
  v_mfma_f32_32x32x16_bf16 v[100:115], v[48:51], v[228:231], v[100:115]
  ds_read_b64_tr_b16 v[48:49], v16 offset:59392
  ds_read_b64_tr_b16 v[50:51], v16 offset:59904
  s_waitcnt lgkmcnt(10)
  v_mfma_f32_32x32x16_bf16 v[80:95], v[52:55], v[232:235], v[80:95]
  ds_read_b64_tr_b16 v[52:53], v15 offset:61440
  ds_read_b64_tr_b16 v[54:55], v15 offset:61952
  s_waitcnt lgkmcnt(10)
  v_mfma_f32_32x32x16_bf16 v[100:115], v[56:59], v[232:235], v[100:115]
  ds_read_b64_tr_b16 v[56:57], v16 offset:61440
  ds_read_b64_tr_b16 v[58:59], v16 offset:61952
  s_waitcnt lgkmcnt(10)
  v_mfma_f32_32x32x16_bf16 v[80:95], v[60:63], v[236:239], v[80:95]
  ds_read_b64_tr_b16 v[60:61], v15 offset:63488
  ds_read_b64_tr_b16 v[62:63], v15 offset:64000
  s_waitcnt lgkmcnt(10)
  v_mfma_f32_32x32x16_bf16 v[100:115], v[252:255], v[236:239], v[100:115]
  ds_read_b64_tr_b16 v[252:253], v16 offset:63488
  ds_read_b64_tr_b16 v[254:255], v16 offset:64000
  s_waitcnt lgkmcnt(10)
  v_mfma_f32_32x32x16_bf16 v[80:95], v[44:47], v[240:243], v[80:95]
  s_waitcnt lgkmcnt(8)
  v_mfma_f32_32x32x16_bf16 v[100:115], v[48:51], v[240:243], v[100:115]
  s_waitcnt lgkmcnt(6)
  v_mfma_f32_32x32x16_bf16 v[80:95], v[52:55], v[244:247], v[80:95]
  s_waitcnt lgkmcnt(4)
  v_mfma_f32_32x32x16_bf16 v[100:115], v[56:59], v[244:247], v[100:115]
  s_waitcnt lgkmcnt(2)
  v_mfma_f32_32x32x16_bf16 v[80:95], v[60:63], v[248:251], v[80:95]
  s_waitcnt lgkmcnt(0)
  v_mfma_f32_32x32x16_bf16 v[100:115], v[252:255], v[248:251], v[100:115]
  s_setprio 0
  s_nop 8
  v_mul_f32 v44, s76, v80
  v_mul_f32 v45, s76, v81
  v_mul_f32 v46, s76, v82
  v_mul_f32 v47, s76, v83
  v_mul_f32 v48, s76, v84
  v_mul_f32 v49, s76, v85
  v_mul_f32 v50, s76, v86
  v_mul_f32 v51, s76, v87
  s_nop 8
  v_mul_f32 v52, s76, v88
  v_mul_f32 v53, s76, v89
  v_mul_f32 v54, s76, v90
  v_mul_f32 v55, s76, v91
  v_mul_f32 v56, s76, v92
  v_mul_f32 v57, s76, v93
  v_mul_f32 v58, s76, v94
  v_mul_f32 v59, s76, v95
  v_exp_f32 v44, v44
  v_exp_f32 v45, v45
  v_exp_f32 v46, v46
  v_exp_f32 v52, v52
  v_exp_f32 v53, v53
  v_exp_f32 v54, v54
  v_exp_f32 v47, v47
  v_exp_f32 v48, v48
  v_exp_f32 v49, v49
  v_exp_f32 v55, v55
  v_exp_f32 v56, v56
  v_exp_f32 v57, v57
  v_exp_f32 v50, v50
  v_exp_f32 v51, v51
  v_exp_f32 v58, v58
  v_exp_f32 v59, v59
  v_add_f32 v44, 1.0, v44
  v_add_f32 v45, 1.0, v45
  v_add_f32 v46, 1.0, v46
  v_add_f32 v47, 1.0, v47
  v_add_f32 v48, 1.0, v48
  v_add_f32 v49, 1.0, v49
  v_add_f32 v50, 1.0, v50
  v_add_f32 v51, 1.0, v51
  v_add_f32 v52, 1.0, v52
  v_add_f32 v53, 1.0, v53
  v_add_f32 v54, 1.0, v54
  v_add_f32 v55, 1.0, v55
  v_add_f32 v56, 1.0, v56
  v_add_f32 v57, 1.0, v57
  v_add_f32 v58, 1.0, v58
  v_add_f32 v59, 1.0, v59
  v_rcp_f32 v44, v44
  v_rcp_f32 v45, v45
  v_rcp_f32 v46, v46
  v_rcp_f32 v52, v52
  v_rcp_f32 v53, v53
  v_rcp_f32 v54, v54
  v_rcp_f32 v47, v47
  v_rcp_f32 v48, v48
  v_rcp_f32 v49, v49
  v_rcp_f32 v55, v55
  v_rcp_f32 v56, v56
  v_rcp_f32 v57, v57
  v_rcp_f32 v50, v50
  v_rcp_f32 v51, v51
  v_rcp_f32 v58, v58
  v_rcp_f32 v59, v59
  v_mul_f32 v44, v80, v44
  v_mul_f32 v45, v81, v45
  v_mul_f32 v46, v82, v46
  v_mul_f32 v47, v83, v47
  v_mul_f32 v48, v84, v48
  v_mul_f32 v49, v85, v49
  v_mul_f32 v50, v86, v50
  v_mul_f32 v51, v87, v51
  v_mul_f32 v52, v88, v52
  v_mul_f32 v53, v89, v53
  v_mul_f32 v54, v90, v54
  v_mul_f32 v55, v91, v55
  v_mul_f32 v56, v92, v56
  v_mul_f32 v57, v93, v57
  v_mul_f32 v58, v94, v58
  v_mul_f32 v59, v95, v59
  s_cmp_lt_u32 s51, 1
  s_cbranch_scc0 F_p1_nf
  buffer_load_dwordx2 v[34:35], v26, s[32:35], s72 offen sc1
  buffer_load_dwordx2 v[36:37], v26, s[32:35], s73 offen sc1
  buffer_load_dwordx2 v[38:39], v27, s[32:35], s74 offen sc1
F_p1_nf:
  v_cvt_pk_bf16_f32 v140, v44, v45
  v_cvt_pk_bf16_f32 v141, v46, v47
  v_cvt_pk_bf16_f32 v142, v48, v49
  v_cvt_pk_bf16_f32 v143, v50, v51
  v_cvt_pk_bf16_f32 v144, v52, v53
  v_cvt_pk_bf16_f32 v145, v54, v55
  v_cvt_pk_bf16_f32 v146, v56, v57
  v_cvt_pk_bf16_f32 v147, v58, v59
  s_nop 11
  v_mul_f32 v44, s76, v100
  v_mul_f32 v45, s76, v101
  v_mul_f32 v46, s76, v102
  v_mul_f32 v47, s76, v103
  v_mul_f32 v48, s76, v104
  v_mul_f32 v49, s76, v105
  v_mul_f32 v50, s76, v106
  v_mul_f32 v51, s76, v107
  s_nop 11
  v_mul_f32 v52, s76, v108
  v_mul_f32 v53, s76, v109
  v_mul_f32 v54, s76, v110
  v_mul_f32 v55, s76, v111
  v_mul_f32 v56, s76, v112
  v_mul_f32 v57, s76, v113
  v_mul_f32 v58, s76, v114
  v_mul_f32 v59, s76, v115
  v_exp_f32 v44, v44
  v_exp_f32 v45, v45
  v_exp_f32 v46, v46
  v_exp_f32 v52, v52
  v_exp_f32 v53, v53
  v_exp_f32 v54, v54
  v_exp_f32 v47, v47
  v_exp_f32 v48, v48
  v_exp_f32 v49, v49
  v_exp_f32 v55, v55
  v_exp_f32 v56, v56
  v_exp_f32 v57, v57
  v_exp_f32 v50, v50
  v_exp_f32 v51, v51
  v_exp_f32 v58, v58
  v_exp_f32 v59, v59
  v_add_f32 v44, 1.0, v44
  v_add_f32 v45, 1.0, v45
  v_add_f32 v46, 1.0, v46
  v_add_f32 v47, 1.0, v47
  v_add_f32 v48, 1.0, v48
  v_add_f32 v49, 1.0, v49
  v_add_f32 v50, 1.0, v50
  v_add_f32 v51, 1.0, v51
  v_add_f32 v52, 1.0, v52
  v_add_f32 v53, 1.0, v53
  v_add_f32 v54, 1.0, v54
  v_add_f32 v55, 1.0, v55
  v_add_f32 v56, 1.0, v56
  v_add_f32 v57, 1.0, v57
  v_add_f32 v58, 1.0, v58
  v_add_f32 v59, 1.0, v59
  v_mov_b32 v41, 160768
  s_mov_b32 s79, 262144
  s_mul_i32 s61, s51, 3
  s_cmp_lt_u32 s51, 1
  s_cselect_b32 s61, s61, 262144
  s_cbranch_scc0 F_p1_st
  s_waitcnt vmcnt(0)
  v_cmp_eq_u64 vcc, s[86:87], v[34:35]
  v_cmp_eq_u64 s[68:69], s[86:87], v[36:37]
  v_cmp_eq_u64 s[70:71], s[86:87], v[38:39]
  s_and_b64 s[68:69], s[68:69], vcc
  s_and_b64 s[68:69], s[68:69], s[70:71]
  s_cmp_eq_u64 s[68:69], exec
  s_cbranch_scc1 F_p1_set
F_p1_st:
  s_cmp_eq_u32 s61, 0
  s_cbranch_scc1 F_p1_issue
  s_sleep 1
  ds_read_b32 v42, v41
  s_waitcnt lgkmcnt(0)
  v_readfirstlane_b32 s63, v42
  s_cmp_lg_u32 s63, 0
  s_cbranch_scc1 F_p1_ok
  s_sub_u32 s61, s61, 1
  s_branch F_p1_st
F_p1_issue:
  buffer_load_dwordx2 v[34:35], v26, s[32:35], s72 offen sc1
  buffer_load_dwordx2 v[36:37], v26, s[32:35], s73 offen sc1
  buffer_load_dwordx2 v[38:39], v27, s[32:35], s74 offen sc1
F_p1_w:
  s_sub_u32 s79, s79, 1
  s_cbranch_scc1 F_p1_ok
  s_sleep 1
  ds_read_b32 v42, v41
  s_waitcnt lgkmcnt(0)
  v_readfirstlane_b32 s63, v42
  s_cmp_lg_u32 s63, 0
  s_cbranch_scc1 F_p1_ok
  s_getreg_b32 s63, hwreg(HW_REG_IB_STS)
  s_and_b32 s63, s63, 0xc0000f
  s_cbranch_scc1 F_p1_w
  s_waitcnt vmcnt(0)
  v_cmp_eq_u64 vcc, s[86:87], v[34:35]
  v_cmp_eq_u64 s[68:69], s[86:87], v[36:37]
  v_cmp_eq_u64 s[70:71], s[86:87], v[38:39]
  s_and_b64 s[68:69], s[68:69], vcc
  s_and_b64 s[68:69], s[68:69], s[70:71]
  s_cmp_eq_u64 s[68:69], exec
  s_cbranch_scc0 F_p1_issue
F_p1_set:
  v_mov_b32 v42, 1
  ds_write_b32 v41, v42
F_p1_ok:
  s_add_u32 m0, s11, 0
  s_add_u32 s74, s10, 0
  buffer_load_dwordx4 v3, s[32:35], s74 offen lds
  s_add_u32 m0, s13, 115584
  s_add_u32 s74, s12, 0
  buffer_load_dwordx4 v3, s[32:35], s74 offen lds
  s_add_u32 m0, s13, 116608
  s_add_u32 s74, s12, 1024
  buffer_load_dwordx4 v3, s[32:35], s74 offen lds
  s_add_u32 m0, s11, 1024
  s_add_u32 s74, s10, 2097152
  buffer_load_dwordx4 v3, s[32:35], s74 offen lds
  s_add_u32 m0, s11, 8256
  s_add_u32 s74, s10, 4096
  buffer_load_dwordx4 v3, s[32:35], s74 offen lds
  s_add_u32 m0, s11, 9280
  s_add_u32 s74, s10, 2101248
  buffer_load_dwordx4 v3, s[32:35], s74 offen lds
  s_add_u32 m0, s11, 16512
  s_add_u32 s74, s10, 8192
  buffer_load_dwordx4 v3, s[32:35], s74 offen lds
  s_add_u32 m0, s11, 17536
  s_add_u32 s74, s10, 2105344
  buffer_load_dwordx4 v3, s[32:35], s74 offen lds
  v_add_u32 v4, 4096, v3
  v_mov_b32 v5, v3
  s_mov_b64 exec, 0x1fff
  ds_write_b128 v8, v[116:119]
  s_mov_b64 exec, -1
  v_rcp_f32 v44, v44
  v_rcp_f32 v45, v45
  v_rcp_f32 v46, v46
  buffer_store_dwordx4 v[140:143], v3, s[32:35], s84 offen offset:0 sc1
  buffer_store_dwordx4 v[144:147], v3, s[32:35], s84 offen offset:1024 sc1
  s_mov_b32 s84, 0x04000000
  v_rcp_f32 v52, v52
  v_rcp_f32 v53, v53
  v_rcp_f32 v54, v54
  v_rcp_f32 v47, v47
  v_rcp_f32 v48, v48
  v_rcp_f32 v49, v49
  v_rcp_f32 v55, v55
  v_rcp_f32 v56, v56
  v_rcp_f32 v57, v57
  v_rcp_f32 v50, v50
  v_rcp_f32 v51, v51
  v_rcp_f32 v58, v58
  v_rcp_f32 v59, v59
  v_mul_f32 v44, v100, v44
  v_mul_f32 v45, v101, v45
  v_mul_f32 v46, v102, v46
  v_mul_f32 v47, v103, v47
  v_mul_f32 v48, v104, v48
  v_mul_f32 v49, v105, v49
  v_mul_f32 v50, v106, v50
  v_mul_f32 v51, v107, v51
  v_mul_f32 v52, v108, v52
  v_mul_f32 v53, v109, v53
  v_mul_f32 v54, v110, v54
  v_mul_f32 v55, v111, v55
  v_mul_f32 v56, v112, v56
  v_mul_f32 v57, v113, v57
  v_mul_f32 v58, v114, v58
  v_mul_f32 v59, v115, v59
  v_cvt_pk_bf16_f32 v148, v44, v45
  v_cvt_pk_bf16_f32 v149, v46, v47
  v_cvt_pk_bf16_f32 v150, v48, v49
  v_cvt_pk_bf16_f32 v151, v50, v51
  v_cvt_pk_bf16_f32 v152, v52, v53
  v_cvt_pk_bf16_f32 v153, v54, v55
  v_cvt_pk_bf16_f32 v154, v56, v57
  v_cvt_pk_bf16_f32 v155, v58, v59
  buffer_store_dwordx4 v[148:151], v3, s[32:35], s101 offen offset:2048 sc1
  buffer_store_dwordx4 v[152:155], v3, s[32:35], s101 offen offset:3072 sc1
  s_mov_b32 s101, 0x04000000
  s_setprio 0
  s_waitcnt lgkmcnt(0)
  s_waitcnt vmcnt(4)
  s_branch F_attn
F_g1:
  s_mov_b32 s32, s18
  s_and_b32 s33, s19, 0xffff
  s_mov_b32 s34, 33554432
  s_mov_b32 s35, 0x20000
  s_mov_b32 s28, s12
  s_and_b32 s29, s13, 0xffff
  s_mov_b32 s30, 1835008
  s_mov_b32 s31, 0x20000
  s_mov_b32 s80, s16
  s_and_b32 s81, s17, 0xffff
  s_mov_b32 s82, 256
  s_mov_b32 s83, 0x20000
  s_lshl_b32 s61, s2, 3
  s_add_u32 s61, s61, s48
  s_cmp_lg_u32 s61, 7
  s_cbranch_scc1 F_noepoch
  s_memrealtime s[62:63]
  v_mov_b32 v18, 0
  s_waitcnt lgkmcnt(0)
  s_or_b32 s63, s63, 0x80000000
  v_mov_b32 v16, s62
  v_mov_b32 v17, s63
  s_mov_b64 exec, 1
  buffer_store_dwordx2 v[16:17], v18, s[80:83], 0 offen sc0 sc1
  s_mov_b64 exec, -1
F_noepoch:
  s_and_b32 s61, s50, 3
  s_and_b32 s63, s49, 1
  s_cmp_eq_u32 s61, 2
  s_cselect_b32 s66, 1, 0
  s_lshl_b32 s61, s61, 3
  s_lshl_b32 s63, s63, 2
  s_add_u32 s61, s61, s63
  s_lshr_b32 s64, 0x65442210, s61
  s_and_b32 s64, s64, 15
  s_lshr_b32 s65, 0x56333301, s61
  s_and_b32 s65, s65, 15
  s_sub_u32 s100, s65, s64
  s_lshl_b32 s100, s100, 7
  s_lshr_b32 s67, s50, 2
  s_mul_i32 s59, s67, 896
  s_lshl_b32 s63, s64, 7
  s_add_u32 s59, s59, s63
  s_mul_i32 s63, s51, 28672
  s_add_u32 s59, s59, s63
  s_lshl_b32 s60, s51, 10
  s_lshl_b32 s62, s52, 1
  s_lshl_b32 s68, s49, 2
  s_add_u32 s68, s68, s51
  s_mul_i32 s68, s68, 112
  s_mul_i32 s67, s67, 28
  s_add_u32 s68, s68, s67
  s_lshl_b32 s65, s65, 1
  s_add_u32 s65, s65, s66
  s_lshl_b32 s65, s65, 1
  s_add_u32 s65, s65, s68
  s_lshl_b32 s65, s65, 10
  s_add_u32 s84, s65, 6291456
  s_add_u32 s61, s50, 1
  s_bitcmp1_b32 s61, 1
  s_cselect_b32 s101, 0x04000000, s84
  v_lshrrev_b32 v16, 3, v2
  v_and_b32 v17, 7, v2
  v_bfe_u32 v18, v2, 4, 1
  v_lshlrev_b32 v18, 2, v18
  v_xor_b32 v17, v17, v18
  v_lshlrev_b32 v17, 4, v17
  v_mul_u32_u24 v16, 3584, v16
  v_add_u32 v7, v16, v17
  v_and_b32 v32, 31, v2
  v_lshrrev_b32 v33, 5, v2
  v_bfe_u32 v34, v2, 1, 3
  v_xor_b32 v34, v34, v33
  v_lshlrev_b32 v34, 4, v34
  s_lshl_b32 s61, s51, 12
  s_add_u32 s61, s61, 57344
  v_lshl_add_u32 v34, v32, 7, v34
  v_add_u32 v10, s61, v34
  v_xor_b32 v11, 32, v10
  v_xor_b32 v12, 64, v10
  v_xor_b32 v13, 96, v10
  v_bfe_u32 v34, v2, 2, 2
  v_lshl_add_u32 v34, v33, 3, v34
  v_and_b32 v35, 1, v2
  v_lshlrev_b32 v35, 4, v35
  v_and_b32 v36, 2, v2
  v_lshl_add_u32 v35, v36, 2, v35
  v_bfe_u32 v36, v2, 4, 1
  v_lshl_add_u32 v35, v36, 5, v35
  v_mul_u32_u24 v37, 192, v34
  v_add3_u32 v14, v37, v35, 0
  v_add_u32 v14, 73728, v14
  v_lshl_add_u32 v37, v34, 7, v35
  v_bfe_u32 v38, v2, 3, 1
  v_lshl_add_u32 v37, v38, 6, v37
  v_xor_b32 v16, 64, v37
  s_lshl_b32 s66, s66, 6
  v_xor_b32 v15, s66, v37
  v_add_u32 v17, 144384, v15
  v_add_u32 v18, 144384, v16
  v_add_u32 v15, 65536, v15
  v_add_u32 v16, 65536, v16
  v_mov_b32 v1, 0
  s_add_u32 s68, s2, 896
  s_cmp_eq_u32 s51, 0
  s_cselect_b32 s74, 0, 0x04000000
  s_sub_u32 s69, s68, 896
  s_cmp_lt_u32 s68, 896
  s_cselect_b32 s68, s68, s69
  s_cselect_b32 s36, s14, s8
  s_cselect_b32 s37, s15, s9
  s_mov_b32 s38, 524288
  s_cselect_b32 s38, 1835008, s38
  s_cselect_b32 s69, 112, 32
  s_cselect_b32 s77, 3, 2
  s_mov_b32 s76, 16777216
  s_cselect_b32 s76, 14680064, s76
  s_cselect_b32 s79, 9, 10
  s_and_b32 s37, s37, 0xffff
  s_mov_b32 s39, 0x20000
  s_lshr_b32 s70, s68, 3
  s_and_b32 s71, s68, 7
  s_lshl_b32 s72, s70, 14
  s_lshl_b32 s73, s71, 7
  s_add_u32 s72, s72, s73
  s_add_u32 s40, s72, s74
  s_add_u32 s41, s40, 8192
  s_mul_i32 s75, s71, s69
  s_lshl_b32 s75, s75, 1
  s_add_u32 s75, s75, s70
  s_lshl_b32 s75, s75, 10
  s_add_u32 s75, s75, s76
  s_add_u32 s42, s75, s74
  s_lshl_b32 s69, s69, 10
  s_add_u32 s43, s42, s69
  s_lshl_b32 s78, s48, 11
  s_add_u32 s78, s78, 132096
  s_lshl_b32 s79, 1, s79
  v_lshrrev_b32 v120, 3, v2
  v_and_b32 v121, 7, v2
  v_lshlrev_b32 v121, 4, v121
  v_lshl_add_u32 v120, v120, 10, v121
  v_lshrrev_b32 v121, 5, v2
  v_lshlrev_b32 v121, s77, v121
  v_bfe_u32 v40, v2, 2, 2
  v_add_u32 v121, v121, v40
  v_lshlrev_b32 v121, 7, v121
  v_bfe_u32 v40, v2, 4, 1
  v_lshl_add_u32 v121, v40, 5, v121
  v_and_b32 v40, 3, v2
  v_lshl_add_u32 v121, v40, 3, v121
  v_add_u32 v121, s78, v121
  v_add_u32 v122, s79, v121
  s_mov_b32 s76, 0xbfb8aa3b
  s_lshl_b32 s64, s49, 2
  s_add_u32 s64, s64, s51
  s_lshl_b32 s65, s64, 10
  s_mul_i32 s5, s50, 6
  s_lshl_b32 s66, s5, 16
  s_add_u32 s4, s65, s66
  s_lshl_b32 s7, s64, 7
  s_add_u32 s7, s7, 17825792
  s_lshl_b32 s67, s50, 1
  s_add_u32 s67, s67, 1
  s_lshl_b32 s67, s67, 6
  s_add_u32 s67, s67, s64
  s_lshl_b32 s67, s67, 3
  s_add_u32 s6, s67, 24117248
  v_lshlrev_b32 v9, 14, v2
  s_and_b32 s70, s2, 7
  s_lshl_b32 s70, s70, 2
  s_bfe_u32 s71, s2, 0x20003
  s_add_u32 s53, s70, s71
  s_lshr_b32 s54, s2, 5
  s_lshl_b32 s19, s53, 1
  s_mov_b32 s85, s54
  s_and_b32 s70, s48, 1
  s_lshr_b32 s71, s48, 1
  s_mul_i32 s8, s70, 2097152
  s_lshl_b32 s75, s53, 16
  s_add_u32 s8, s8, s75
  s_lshl_b32 s75, s71, 10
  s_add_u32 s8, s8, s75
  s_add_u32 s8, s8, 2097152
  s_mul_i32 s9, s71, 2064
  s_lshl_b32 s75, s70, 10
  s_add_u32 s9, s9, s75
  v_bfe_u32 v32, v2, 1, 1
  v_lshlrev_b32 v36, 3, v32
  v_add_u32 v36, 2048, v36
  v_lshlrev_b32 v32, 9, v32
  v_bfe_u32 v33, v2, 2, 2
  v_lshl_add_u32 v32, v33, 4, v32
  v_lshrrev_b32 v33, 5, v2
  v_lshl_add_u32 v32, v33, 7, v32
  v_and_b32 v33, 1, v2
  v_lshl_add_u32 v32, v33, 3, v32
  v_and_b32 v33, 16, v2
  v_cmp_eq_u32 vcc, 0, v33
  v_add_u32 v37, 1024, v32
  v_add_u32 v38, 1088, v32
  v_add_u32 v39, 1280, v32
  v_add_u32 v40, 1344, v32
  v_cndmask_b32 v96, v36, v37, vcc
  v_cndmask_b32 v97, v36, v38, vcc
  v_cndmask_b32 v98, v36, v39, vcc
  v_cndmask_b32 v99, v36, v40, vcc
  s_add_u32 s70, s9, 115584
  v_add_u32 v123, s70, v3
  v_mul_u32_u24 v8, 2064, v2
  v_add_u32 v8, 2048, v8
  v_mov_b32 v116, 0x3f80
  v_mov_b32 v117, 0
  v_mov_b32 v118, 0
  v_mov_b32 v119, 0
  s_and_b32 s71, s48, 1
  s_add_u32 s19, s19, s71
  s_lshr_b32 s3, s48, 1
  s_lshl_b32 s18, s19, 7
  s_add_u32 s18, s18, 17825792
  s_lshl_b32 s17, s54, 3
  s_add_u32 s17, s17, s48
  s_lshl_b32 s17, s17, 7
  s_add_u32 s17, s17, 17825792
  s_mul_i32 s71, s3, 28
  s_mul_i32 s70, s19, 112
  s_add_u32 s70, s70, s71
  s_lshl_b32 s70, s70, 10
  s_add_u32 s15, s70, 6291456
  s_mul_i32 s70, s85, 224
  s_add_u32 s70, s70, s71
  s_lshl_b32 s70, s70, 10
  s_add_u32 s14, s70, 14680064
  s_add_u32 s16, s14, 114688
  s_lshl_b32 s70, s3, 3
  s_lshl_b32 s71, s85, 6
  s_add_u32 s71, s71, s70
  s_lshl_b32 s71, s71, 10
  s_add_u32 s98, s71, 16777216
  s_add_u32 s99, s98, 32768
  s_cmp_ge_u32 s48, 4
  s_cselect_b64 s[96:97], -1, 0
  s_add_u32 s58, s52, 1
  s_and_b32 s58, s58, 7
  s_mul_i32 s58, s58, 196608
  s_add_u32 s58, s58, s55
  s_add_u32 m0, s56, 102400
  s_nop 0
  buffer_load_dwordx4 v4, s[24:27], s58 offen lds
  s_add_u32 m0, s56, 103424
  s_nop 0
  buffer_load_dwordx4 v5, s[24:27], s58 offen lds
  s_add_u32 m0, s56, 104448
  s_nop 0
  buffer_load_dwordx4 v6, s[24:27], s58 offen lds
  s_add_u32 s58, s52, 2
  s_and_b32 s58, s58, 7
  s_mul_i32 s58, s58, 196608
  s_add_u32 s58, s58, s55
  s_add_u32 m0, s56, 131072
  s_nop 0
  buffer_load_dwordx4 v4, s[24:27], s58 offen lds
  s_add_u32 m0, s56, 132096
  s_nop 0
  buffer_load_dwordx4 v5, s[24:27], s58 offen lds
  s_add_u32 m0, s56, 133120
  s_nop 0
  buffer_load_dwordx4 v6, s[24:27], s58 offen lds
  s_waitcnt vmcnt(6)
  s_waitcnt lgkmcnt(0)
  s_barrier
  ds_read_b128 v[124:127], v10 offset:0
  ds_read_b64_tr_b16 v[44:45], v14 offset:0
  ds_read_b64_tr_b16 v[46:47], v14 offset:768
  ds_read_b64_tr_b16 v[48:49], v14 offset:64
  ds_read_b64_tr_b16 v[50:51], v14 offset:832
  ds_read_b128 v[128:131], v11 offset:0
  ds_read_b64_tr_b16 v[52:53], v14 offset:3072
  ds_read_b64_tr_b16 v[54:55], v14 offset:3840
  ds_read_b64_tr_b16 v[56:57], v14 offset:3136
  ds_read_b64_tr_b16 v[58:59], v14 offset:3904
  ds_read_b128 v[132:135], v12 offset:0
  ds_read_b64_tr_b16 v[60:61], v14 offset:6144
  ds_read_b64_tr_b16 v[62:63], v14 offset:6912
  ds_read_b64_tr_b16 v[252:253], v14 offset:6208
  ds_read_b64_tr_b16 v[254:255], v14 offset:6976
  s_waitcnt lgkmcnt(12)
  v_mfma_f32_32x32x16_bf16 v[64:79], v[44:47], v[124:127], 0
  ds_read_b128 v[136:139], v13 offset:0
  ds_read_b64_tr_b16 v[44:45], v14 offset:9216
  ds_read_b64_tr_b16 v[46:47], v14 offset:9984
  s_add_u32 s58, s52, 3
  s_and_b32 s58, s58, 7
  s_mul_i32 s58, s58, 196608
  s_add_u32 s58, s58, s55
  s_add_u32 m0, s56, 16384
  s_nop 0
  buffer_load_dwordx4 v4, s[24:27], s58 offen lds
  s_waitcnt lgkmcnt(13)
  v_mfma_f32_32x32x16_bf16 v[100:115], v[48:51], v[124:127], 0
  ds_read_b64_tr_b16 v[48:49], v14 offset:9280
  ds_read_b64_tr_b16 v[50:51], v14 offset:10048
  s_add_u32 m0, s56, 17408
  s_nop 0
  buffer_load_dwordx4 v5, s[24:27], s58 offen lds
  s_waitcnt lgkmcnt(12)
  v_mfma_f32_32x32x16_bf16 v[64:79], v[52:55], v[128:131], v[64:79]
  s_add_u32 m0, s56, 18432
  s_nop 0
  buffer_load_dwordx4 v6, s[24:27], s58 offen lds
  s_waitcnt lgkmcnt(10)
  v_mfma_f32_32x32x16_bf16 v[100:115], v[56:59], v[128:131], v[100:115]
  s_waitcnt vmcnt(6)
  s_barrier
  ds_read_b128 v[140:143], v10 offset:28672
  ds_read_b64_tr_b16 v[52:53], v14 offset:28672
  ds_read_b64_tr_b16 v[54:55], v14 offset:29440
  ds_read_b64_tr_b16 v[56:57], v14 offset:28736
  ds_read_b64_tr_b16 v[58:59], v14 offset:29504
  s_add_u32 s58, s52, 4
  s_and_b32 s58, s58, 7
  s_mul_i32 s58, s58, 196608
  s_add_u32 s58, s58, s55
  s_add_u32 m0, s56, 45056
  s_nop 0
  buffer_load_dwordx4 v4, s[24:27], s58 offen lds
  s_waitcnt lgkmcnt(12)
  v_mfma_f32_32x32x16_bf16 v[64:79], v[60:63], v[132:135], v[64:79]
  ds_read_b128 v[144:147], v11 offset:28672
  ds_read_b64_tr_b16 v[60:61], v14 offset:31744
  ds_read_b64_tr_b16 v[62:63], v14 offset:32512
  s_add_u32 m0, s56, 46080
  s_nop 0
  buffer_load_dwordx4 v5, s[24:27], s58 offen lds
  s_waitcnt lgkmcnt(13)
  v_mfma_f32_32x32x16_bf16 v[100:115], v[252:255], v[132:135], v[100:115]
  ds_read_b64_tr_b16 v[252:253], v14 offset:31808
  ds_read_b64_tr_b16 v[254:255], v14 offset:32576
  s_add_u32 m0, s56, 47104
  s_nop 0
  buffer_load_dwordx4 v6, s[24:27], s58 offen lds
  s_waitcnt lgkmcnt(12)
  v_mfma_f32_32x32x16_bf16 v[64:79], v[44:47], v[136:139], v[64:79]
  ds_read_b128 v[148:151], v12 offset:28672
  ds_read_b64_tr_b16 v[44:45], v14 offset:34816
  ds_read_b64_tr_b16 v[46:47], v14 offset:35584
  s_waitcnt lgkmcnt(13)
  v_mfma_f32_32x32x16_bf16 v[100:115], v[48:51], v[136:139], v[100:115]
  ds_read_b64_tr_b16 v[48:49], v14 offset:34880
  ds_read_b64_tr_b16 v[50:51], v14 offset:35648
  s_waitcnt lgkmcnt(12)
  v_mfma_f32_32x32x16_bf16 v[64:79], v[52:55], v[140:143], v[64:79]
  ds_read_b128 v[152:155], v13 offset:28672
  ds_read_b64_tr_b16 v[52:53], v14 offset:37888
  ds_read_b64_tr_b16 v[54:55], v14 offset:38656
  s_waitcnt lgkmcnt(13)
  v_mfma_f32_32x32x16_bf16 v[100:115], v[56:59], v[140:143], v[100:115]
  ds_read_b64_tr_b16 v[56:57], v14 offset:37952
  ds_read_b64_tr_b16 v[58:59], v14 offset:38720
  s_waitcnt lgkmcnt(12)
  v_mfma_f32_32x32x16_bf16 v[64:79], v[60:63], v[144:147], v[64:79]
  s_waitcnt lgkmcnt(10)
  v_mfma_f32_32x32x16_bf16 v[100:115], v[252:255], v[144:147], v[100:115]
  s_waitcnt vmcnt(6)
  s_barrier
  v_add_u32 v10, 57344, v10
  v_add_u32 v11, 57344, v11
  v_add_u32 v12, 57344, v12
  v_add_u32 v13, 57344, v13
  v_add_u32 v14, 57344, v14
  ds_read_b128 v[156:159], v10 offset:0
  ds_read_b64_tr_b16 v[60:61], v14 offset:0
  ds_read_b64_tr_b16 v[62:63], v14 offset:768
  ds_read_b64_tr_b16 v[252:253], v14 offset:64
  ds_read_b64_tr_b16 v[254:255], v14 offset:832
  s_add_u32 s58, s52, 5
  s_and_b32 s58, s58, 7
  s_mul_i32 s58, s58, 196608
  s_add_u32 s58, s58, s55
  s_add_u32 m0, s56, 73728
  s_nop 0
  buffer_load_dwordx4 v4, s[24:27], s58 offen lds
  s_waitcnt lgkmcnt(12)
  v_mfma_f32_32x32x16_bf16 v[64:79], v[44:47], v[148:151], v[64:79]
  ds_read_b128 v[160:163], v11 offset:0
  ds_read_b64_tr_b16 v[44:45], v14 offset:3072
  ds_read_b64_tr_b16 v[46:47], v14 offset:3840
  s_add_u32 m0, s56, 74752
  s_nop 0
  buffer_load_dwordx4 v5, s[24:27], s58 offen lds
  s_waitcnt lgkmcnt(13)
  v_mfma_f32_32x32x16_bf16 v[100:115], v[48:51], v[148:151], v[100:115]
  ds_read_b64_tr_b16 v[48:49], v14 offset:3136
  ds_read_b64_tr_b16 v[50:51], v14 offset:3904
  s_add_u32 m0, s56, 75776
  s_nop 0
  buffer_load_dwordx4 v6, s[24:27], s58 offen lds
  s_waitcnt lgkmcnt(12)
  v_mfma_f32_32x32x16_bf16 v[64:79], v[52:55], v[152:155], v[64:79]
  ds_read_b128 v[164:167], v12 offset:0
  ds_read_b64_tr_b16 v[52:53], v14 offset:6144
  ds_read_b64_tr_b16 v[54:55], v14 offset:6912
  s_waitcnt lgkmcnt(13)
  v_mfma_f32_32x32x16_bf16 v[100:115], v[56:59], v[152:155], v[100:115]
  ds_read_b64_tr_b16 v[56:57], v14 offset:6208
  ds_read_b64_tr_b16 v[58:59], v14 offset:6976
  s_waitcnt lgkmcnt(12)
  v_mfma_f32_32x32x16_bf16 v[64:79], v[60:63], v[156:159], v[64:79]
  ds_read_b128 v[168:171], v13 offset:0
  ds_read_b64_tr_b16 v[60:61], v14 offset:9216
  ds_read_b64_tr_b16 v[62:63], v14 offset:9984
  s_waitcnt lgkmcnt(13)
  v_mfma_f32_32x32x16_bf16 v[100:115], v[252:255], v[156:159], v[100:115]
  ds_read_b64_tr_b16 v[252:253], v14 offset:9280
  ds_read_b64_tr_b16 v[254:255], v14 offset:10048
  s_waitcnt lgkmcnt(12)
  v_mfma_f32_32x32x16_bf16 v[64:79], v[44:47], v[160:163], v[64:79]
  s_waitcnt lgkmcnt(10)
  v_mfma_f32_32x32x16_bf16 v[100:115], v[48:51], v[160:163], v[100:115]
  s_waitcnt vmcnt(6)
  s_barrier
  v_add_u32 v10, 4294852608, v10
  v_add_u32 v11, 4294852608, v11
  v_add_u32 v12, 4294852608, v12
  v_add_u32 v13, 4294852608, v13
  v_add_u32 v14, 4294852608, v14
  ds_read_b128 v[172:175], v10 offset:0
  ds_read_b64_tr_b16 v[44:45], v14 offset:0
  ds_read_b64_tr_b16 v[46:47], v14 offset:768
  ds_read_b64_tr_b16 v[48:49], v14 offset:64
  ds_read_b64_tr_b16 v[50:51], v14 offset:832
  s_add_u32 s58, s52, 6
  s_and_b32 s58, s58, 7
  s_mul_i32 s58, s58, 196608
  s_add_u32 s58, s58, s55
  s_add_u32 m0, s56, 102400
  s_nop 0
  buffer_load_dwordx4 v4, s[24:27], s58 offen lds
  s_waitcnt lgkmcnt(12)
  v_mfma_f32_32x32x16_bf16 v[64:79], v[52:55], v[164:167], v[64:79]
  ds_read_b128 v[176:179], v11 offset:0
  ds_read_b64_tr_b16 v[52:53], v14 offset:3072
  ds_read_b64_tr_b16 v[54:55], v14 offset:3840
  s_add_u32 m0, s56, 103424
  s_nop 0
  buffer_load_dwordx4 v5, s[24:27], s58 offen lds
  s_waitcnt lgkmcnt(13)
  v_mfma_f32_32x32x16_bf16 v[100:115], v[56:59], v[164:167], v[100:115]
  ds_read_b64_tr_b16 v[56:57], v14 offset:3136
  ds_read_b64_tr_b16 v[58:59], v14 offset:3904
  s_add_u32 m0, s56, 104448
  s_nop 0
  buffer_load_dwordx4 v6, s[24:27], s58 offen lds
  s_waitcnt lgkmcnt(12)
  v_mfma_f32_32x32x16_bf16 v[64:79], v[60:63], v[168:171], v[64:79]
  ds_read_b128 v[180:183], v12 offset:0
  ds_read_b64_tr_b16 v[60:61], v14 offset:6144
  ds_read_b64_tr_b16 v[62:63], v14 offset:6912
  s_waitcnt lgkmcnt(13)
  v_mfma_f32_32x32x16_bf16 v[100:115], v[252:255], v[168:171], v[100:115]
  ds_read_b64_tr_b16 v[252:253], v14 offset:6208
  ds_read_b64_tr_b16 v[254:255], v14 offset:6976
  s_waitcnt lgkmcnt(12)
  v_mfma_f32_32x32x16_bf16 v[64:79], v[44:47], v[172:175], v[64:79]
  ds_read_b128 v[184:187], v13 offset:0
  ds_read_b64_tr_b16 v[44:45], v14 offset:9216
  ds_read_b64_tr_b16 v[46:47], v14 offset:9984
  s_waitcnt lgkmcnt(13)
  v_mfma_f32_32x32x16_bf16 v[100:115], v[48:51], v[172:175], v[100:115]
  ds_read_b64_tr_b16 v[48:49], v14 offset:9280
  ds_read_b64_tr_b16 v[50:51], v14 offset:10048
  s_waitcnt lgkmcnt(12)
  v_mfma_f32_32x32x16_bf16 v[64:79], v[52:55], v[176:179], v[64:79]
  s_waitcnt lgkmcnt(10)
  v_mfma_f32_32x32x16_bf16 v[100:115], v[56:59], v[176:179], v[100:115]
  s_waitcnt vmcnt(6)
  s_barrier
  ds_read_b128 v[188:191], v10 offset:28672
  ds_read_b64_tr_b16 v[52:53], v14 offset:28672
  ds_read_b64_tr_b16 v[54:55], v14 offset:29440
  ds_read_b64_tr_b16 v[56:57], v14 offset:28736
  ds_read_b64_tr_b16 v[58:59], v14 offset:29504
  s_add_u32 s58, s52, 7
  s_and_b32 s58, s58, 7
  s_mul_i32 s58, s58, 196608
  s_add_u32 s58, s58, s55
  s_add_u32 m0, s56, 131072
  s_nop 0
  buffer_load_dwordx4 v4, s[24:27], s58 offen lds
  s_waitcnt lgkmcnt(12)
  v_mfma_f32_32x32x16_bf16 v[64:79], v[60:63], v[180:183], v[64:79]
  ds_read_b128 v[192:195], v11 offset:28672
  ds_read_b64_tr_b16 v[60:61], v14 offset:31744
  ds_read_b64_tr_b16 v[62:63], v14 offset:32512
  s_add_u32 m0, s56, 132096
  s_nop 0
  buffer_load_dwordx4 v5, s[24:27], s58 offen lds
  s_waitcnt lgkmcnt(13)
  v_mfma_f32_32x32x16_bf16 v[100:115], v[252:255], v[180:183], v[100:115]
  ds_read_b64_tr_b16 v[252:253], v14 offset:31808
  ds_read_b64_tr_b16 v[254:255], v14 offset:32576
  s_add_u32 m0, s56, 133120
  s_nop 0
  buffer_load_dwordx4 v6, s[24:27], s58 offen lds
  s_waitcnt lgkmcnt(12)
  v_mfma_f32_32x32x16_bf16 v[64:79], v[44:47], v[184:187], v[64:79]
  ds_read_b128 v[196:199], v12 offset:28672
  ds_read_b64_tr_b16 v[44:45], v14 offset:34816
  ds_read_b64_tr_b16 v[46:47], v14 offset:35584
  s_waitcnt lgkmcnt(13)
  v_mfma_f32_32x32x16_bf16 v[100:115], v[48:51], v[184:187], v[100:115]
  ds_read_b64_tr_b16 v[48:49], v14 offset:34880
  ds_read_b64_tr_b16 v[50:51], v14 offset:35648
  s_waitcnt lgkmcnt(12)
  v_mfma_f32_32x32x16_bf16 v[64:79], v[52:55], v[188:191], v[64:79]
  ds_read_b128 v[200:203], v13 offset:28672
  ds_read_b64_tr_b16 v[52:53], v14 offset:37888
  ds_read_b64_tr_b16 v[54:55], v14 offset:38656
  s_waitcnt lgkmcnt(13)
  v_mfma_f32_32x32x16_bf16 v[100:115], v[56:59], v[188:191], v[100:115]
  ds_read_b64_tr_b16 v[56:57], v14 offset:37952
  ds_read_b64_tr_b16 v[58:59], v14 offset:38720
  s_waitcnt lgkmcnt(12)
  v_mfma_f32_32x32x16_bf16 v[64:79], v[60:63], v[192:195], v[64:79]
  s_waitcnt lgkmcnt(10)
  v_mfma_f32_32x32x16_bf16 v[100:115], v[252:255], v[192:195], v[100:115]
  s_waitcnt vmcnt(6)
  s_barrier
  v_add_u32 v10, 57344, v10
  v_add_u32 v11, 57344, v11
  v_add_u32 v12, 57344, v12
  v_add_u32 v13, 57344, v13
  v_add_u32 v14, 57344, v14
  ds_read_b128 v[204:207], v10 offset:0
  ds_read_b64_tr_b16 v[60:61], v14 offset:0
  ds_read_b64_tr_b16 v[62:63], v14 offset:768
  ds_read_b64_tr_b16 v[252:253], v14 offset:64
  ds_read_b64_tr_b16 v[254:255], v14 offset:832
  buffer_load_dwordx2 v[30:31], v1, s[80:83], 0 offen sc0 sc1
  s_waitcnt lgkmcnt(12)
  v_mfma_f32_32x32x16_bf16 v[64:79], v[44:47], v[196:199], v[64:79]
  ds_read_b128 v[208:211], v11 offset:0
  ds_read_b64_tr_b16 v[44:45], v14 offset:3072
  ds_read_b64_tr_b16 v[46:47], v14 offset:3840
  s_waitcnt lgkmcnt(13)
  v_mfma_f32_32x32x16_bf16 v[100:115], v[48:51], v[196:199], v[100:115]
  ds_read_b64_tr_b16 v[48:49], v14 offset:3136
  ds_read_b64_tr_b16 v[50:51], v14 offset:3904
  s_waitcnt lgkmcnt(12)
  v_mfma_f32_32x32x16_bf16 v[64:79], v[52:55], v[200:203], v[64:79]
  ds_read_b128 v[212:215], v12 offset:0
  ds_read_b64_tr_b16 v[52:53], v14 offset:6144
  ds_read_b64_tr_b16 v[54:55], v14 offset:6912
  s_waitcnt lgkmcnt(13)
  v_mfma_f32_32x32x16_bf16 v[100:115], v[56:59], v[200:203], v[100:115]
  ds_read_b64_tr_b16 v[56:57], v14 offset:6208
  ds_read_b64_tr_b16 v[58:59], v14 offset:6976
  s_waitcnt lgkmcnt(12)
  v_mfma_f32_32x32x16_bf16 v[64:79], v[60:63], v[204:207], v[64:79]
  ds_read_b128 v[216:219], v13 offset:0
  ds_read_b64_tr_b16 v[60:61], v14 offset:9216
  ds_read_b64_tr_b16 v[62:63], v14 offset:9984
  s_waitcnt lgkmcnt(13)
  v_mfma_f32_32x32x16_bf16 v[100:115], v[252:255], v[204:207], v[100:115]
  ds_read_b64_tr_b16 v[252:253], v14 offset:9280
  ds_read_b64_tr_b16 v[254:255], v14 offset:10048
  s_waitcnt lgkmcnt(12)
  v_mfma_f32_32x32x16_bf16 v[64:79], v[44:47], v[208:211], v[64:79]
  s_waitcnt lgkmcnt(10)
  v_mfma_f32_32x32x16_bf16 v[100:115], v[48:51], v[208:211], v[100:115]
  s_waitcnt vmcnt(4)
  s_barrier
  ds_read_b128 v[220:223], v10 offset:28672
  ds_read_b64_tr_b16 v[44:45], v14 offset:28672
  ds_read_b64_tr_b16 v[46:47], v14 offset:29440
  ds_read_b64_tr_b16 v[48:49], v14 offset:28736
  ds_read_b64_tr_b16 v[50:51], v14 offset:29504
  s_waitcnt lgkmcnt(12)
  v_mfma_f32_32x32x16_bf16 v[64:79], v[52:55], v[212:215], v[64:79]
  ds_read_b128 v[224:227], v11 offset:28672
  ds_read_b64_tr_b16 v[52:53], v14 offset:31744
  ds_read_b64_tr_b16 v[54:55], v14 offset:32512
  s_waitcnt lgkmcnt(13)
  v_mfma_f32_32x32x16_bf16 v[100:115], v[56:59], v[212:215], v[100:115]
  ds_read_b64_tr_b16 v[56:57], v14 offset:31808
  ds_read_b64_tr_b16 v[58:59], v14 offset:32576
  s_waitcnt lgkmcnt(12)
  v_mfma_f32_32x32x16_bf16 v[64:79], v[60:63], v[216:219], v[64:79]
  ds_read_b128 v[228:231], v12 offset:28672
  ds_read_b64_tr_b16 v[60:61], v14 offset:34816
  ds_read_b64_tr_b16 v[62:63], v14 offset:35584
  s_waitcnt lgkmcnt(13)
  v_mfma_f32_32x32x16_bf16 v[100:115], v[252:255], v[216:219], v[100:115]
  ds_read_b64_tr_b16 v[252:253], v14 offset:34880
  ds_read_b64_tr_b16 v[254:255], v14 offset:35648
  s_waitcnt lgkmcnt(12)
  v_mfma_f32_32x32x16_bf16 v[64:79], v[44:47], v[220:223], v[64:79]
  ds_read_b128 v[232:235], v13 offset:28672
  ds_read_b64_tr_b16 v[44:45], v14 offset:37888
  ds_read_b64_tr_b16 v[46:47], v14 offset:38656
  s_waitcnt lgkmcnt(13)
  v_mfma_f32_32x32x16_bf16 v[100:115], v[48:51], v[220:223], v[100:115]
  ds_read_b64_tr_b16 v[48:49], v14 offset:37952
  ds_read_b64_tr_b16 v[50:51], v14 offset:38720
  s_waitcnt lgkmcnt(12)
  v_mfma_f32_32x32x16_bf16 v[64:79], v[52:55], v[224:227], v[64:79]
  s_waitcnt lgkmcnt(10)
  v_mfma_f32_32x32x16_bf16 v[100:115], v[56:59], v[224:227], v[100:115]
  s_waitcnt vmcnt(1)
  s_waitcnt lgkmcnt(0)
  s_barrier
  v_add_u32 v10, 57344, v10
  v_add_u32 v11, 57344, v11
  v_add_u32 v12, 57344, v12
  v_add_u32 v13, 57344, v13
  v_add_u32 v14, 57344, v14
  ds_read_b128 v[236:239], v10 offset:0
  ds_read_b64_tr_b16 v[52:53], v14 offset:0
  ds_read_b64_tr_b16 v[54:55], v14 offset:768
  ds_read_b64_tr_b16 v[56:57], v14 offset:64
  ds_read_b64_tr_b16 v[58:59], v14 offset:832
  v_mfma_f32_32x32x16_bf16 v[64:79], v[60:63], v[228:231], v[64:79]
  ds_read_b128 v[240:243], v11 offset:0
  ds_read_b64_tr_b16 v[60:61], v14 offset:3072
  ds_read_b64_tr_b16 v[62:63], v14 offset:3840
  v_mfma_f32_32x32x16_bf16 v[100:115], v[252:255], v[228:231], v[100:115]
  ds_read_b64_tr_b16 v[252:253], v14 offset:3136
  ds_read_b64_tr_b16 v[254:255], v14 offset:3904
  v_mfma_f32_32x32x16_bf16 v[64:79], v[44:47], v[232:235], v[64:79]
  ds_read_b128 v[244:247], v12 offset:0
  ds_read_b64_tr_b16 v[44:45], v14 offset:6144
  ds_read_b64_tr_b16 v[46:47], v14 offset:6912
  v_mfma_f32_32x32x16_bf16 v[100:115], v[48:51], v[232:235], v[100:115]
  ds_read_b128 v[248:251], v13 offset:0
  ds_read_b64_tr_b16 v[48:49], v14 offset:9216
  ds_read_b64_tr_b16 v[50:51], v14 offset:9984
  s_waitcnt lgkmcnt(13)
  v_mfma_f32_32x32x16_bf16 v[64:79], v[52:55], v[236:239], v[64:79]
  ds_read_b64_tr_b16 v[52:53], v14 offset:6208
  ds_read_b64_tr_b16 v[54:55], v14 offset:6976
  s_waitcnt lgkmcnt(13)
  v_mfma_f32_32x32x16_bf16 v[100:115], v[56:59], v[236:239], v[100:115]
  ds_read_b64_tr_b16 v[56:57], v14 offset:9280
  ds_read_b64_tr_b16 v[58:59], v14 offset:10048
  s_waitcnt lgkmcnt(12)
  v_mfma_f32_32x32x16_bf16 v[64:79], v[60:63], v[240:243], v[64:79]
  s_waitcnt lgkmcnt(10)
  v_mfma_f32_32x32x16_bf16 v[100:115], v[252:255], v[240:243], v[100:115]
  s_barrier
  s_waitcnt lgkmcnt(7)
  v_mfma_f32_32x32x16_bf16 v[64:79], v[44:47], v[244:247], v[64:79]
  s_waitcnt lgkmcnt(4)
  v_mfma_f32_32x32x16_bf16 v[64:79], v[48:51], v[248:251], v[64:79]
  s_waitcnt lgkmcnt(2)
  v_mfma_f32_32x32x16_bf16 v[100:115], v[52:55], v[244:247], v[100:115]
  s_waitcnt lgkmcnt(0)
  v_mfma_f32_32x32x16_bf16 v[100:115], v[56:59], v[248:251], v[100:115]
  s_nop 4
  s_cmp_lt_u32 s5, 32
  s_cselect_b32 s66, 0x3eb8aa3b, 1.0
  s_cbranch_scc0 F_nq1_0
  v_mul_f32 v64, s66, v64
  v_mul_f32 v65, s66, v65
  v_mul_f32 v66, s66, v66
  v_mul_f32 v67, s66, v67
  v_mul_f32 v68, s66, v68
  v_mul_f32 v69, s66, v69
  v_mul_f32 v70, s66, v70
  v_mul_f32 v71, s66, v71
F_nq1_0:
  s_add_u32 s67, s4, 0
  v_cvt_pk_bf16_f32 v32, v64, v65
  v_cvt_pk_bf16_f32 v33, v66, v67
  v_cvt_pk_bf16_f32 v34, v68, v69
  v_cvt_pk_bf16_f32 v35, v70, v71
  buffer_store_dwordx4 v[32:35], v3, s[32:35], s67 offen sc1
  s_cmp_lt_u32 s5, 31
  s_cselect_b32 s66, 0x3eb8aa3b, 1.0
  s_cbranch_scc0 F_nq1_1
  v_mul_f32 v72, s66, v72
  v_mul_f32 v73, s66, v73
  v_mul_f32 v74, s66, v74
  v_mul_f32 v75, s66, v75
  v_mul_f32 v76, s66, v76
  v_mul_f32 v77, s66, v77
  v_mul_f32 v78, s66, v78
  v_mul_f32 v79, s66, v79
F_nq1_1:
  s_add_u32 s67, s4, 65536
  v_cvt_pk_bf16_f32 v36, v72, v73
  v_cvt_pk_bf16_f32 v37, v74, v75
  v_cvt_pk_bf16_f32 v38, v76, v77
  v_cvt_pk_bf16_f32 v39, v78, v79
  buffer_store_dwordx4 v[36:39], v3, s[32:35], s67 offen sc1
  s_cmp_lt_u32 s5, 30
  s_cselect_b32 s66, 0x3eb8aa3b, 1.0
  s_cbranch_scc0 F_nq1_2
  v_mul_f32 v100, s66, v100
  v_mul_f32 v101, s66, v101
  v_mul_f32 v102, s66, v102
  v_mul_f32 v103, s66, v103
  v_mul_f32 v104, s66, v104
  v_mul_f32 v105, s66, v105
  v_mul_f32 v106, s66, v106
  v_mul_f32 v107, s66, v107
F_nq1_2:
  s_add_u32 s67, s4, 131072
  v_cvt_pk_bf16_f32 v40, v100, v101
  v_cvt_pk_bf16_f32 v41, v102, v103
  v_cvt_pk_bf16_f32 v42, v104, v105
  v_cvt_pk_bf16_f32 v43, v106, v107
  buffer_store_dwordx4 v[40:43], v3, s[32:35], s67 offen sc1
  s_cmp_lt_u32 s5, 29
  s_cselect_b32 s66, 0x3eb8aa3b, 1.0
  s_cbranch_scc0 F_nq1_3
  v_mul_f32 v108, s66, v108
  v_mul_f32 v109, s66, v109
  v_mul_f32 v110, s66, v110
  v_mul_f32 v111, s66, v111
  v_mul_f32 v112, s66, v112
  v_mul_f32 v113, s66, v113
  v_mul_f32 v114, s66, v114
  v_mul_f32 v115, s66, v115
F_nq1_3:
  s_add_u32 s67, s4, 196608
  v_cvt_pk_bf16_f32 v32, v108, v109
  v_cvt_pk_bf16_f32 v33, v110, v111
  v_cvt_pk_bf16_f32 v34, v112, v113
  v_cvt_pk_bf16_f32 v35, v114, v115
  buffer_store_dwordx4 v[32:35], v3, s[32:35], s67 offen sc1
  s_setprio 0
  s_waitcnt vmcnt(4)
  v_readfirstlane_b32 s86, v30
  v_readfirstlane_b32 s87, v31
  s_cmp_lg_u32 s87, 0
  s_cbranch_scc1 F_ep1_ok
  s_mov_b32 s79, 32768
F_ep1_retry:
  s_sleep 2
  buffer_load_dwordx2 v[30:31], v1, s[80:83], 0 offen sc0 sc1
  s_waitcnt vmcnt(0)
  v_readfirstlane_b32 s86, v30
  v_readfirstlane_b32 s87, v31
  s_cmp_lg_u32 s87, 0
  s_cbranch_scc1 F_ep1_ok
  s_sub_u32 s79, s79, 1
  s_cmp_lg_u32 s79, 0
  s_cbranch_scc1 F_ep1_retry
F_ep1_ok:
  s_add_u32 s61, s50, 1
  s_bitcmp1_b32 s61, 1
  s_cbranch_scc1 F_light
  s_barrier
  ds_read_b64_tr_b16 v[60:61], v15 offset:0
  ds_read_b64_tr_b16 v[62:63], v15 offset:512
  ds_read_b64_tr_b16 v[252:253], v16 offset:0
  ds_read_b64_tr_b16 v[254:255], v16 offset:512
  ds_read_b64_tr_b16 v[44:45], v15 offset:2048
  ds_read_b64_tr_b16 v[46:47], v15 offset:2560
  ds_read_b64_tr_b16 v[48:49], v16 offset:2048
  ds_read_b64_tr_b16 v[50:51], v16 offset:2560
  ds_read_b64_tr_b16 v[52:53], v15 offset:4096
  ds_read_b64_tr_b16 v[54:55], v15 offset:4608
  ds_read_b64_tr_b16 v[56:57], v16 offset:4096
  ds_read_b64_tr_b16 v[58:59], v16 offset:4608
  s_waitcnt lgkmcnt(10)
  v_mfma_f32_32x32x16_bf16 v[80:95], v[60:63], v[124:127], 0
  s_mov_b32 s66, 0
  s_getreg_b32 s65, hwreg(HW_REG_IB_STS)
  s_and_b32 s65, s65, 0xc0000f
  s_cmp_gt_u32 s65, 0
  s_cbranch_scc1 F_pb1h_1
  s_mov_b64 exec, 255
  buffer_store_dwordx2 v[30:31], v9, s[32:35], s6 offen sc1
  s_mov_b64 exec, -1
  s_mov_b32 s66, 1
F_pb1h_1:
  ds_read_b64_tr_b16 v[60:61], v15 offset:6144
  ds_read_b64_tr_b16 v[62:63], v15 offset:6656
  s_setprio 1
  s_waitcnt lgkmcnt(10)
  v_mfma_f32_32x32x16_bf16 v[64:79], v[252:255], v[124:127], 0
  s_cmp_lg_u32 s66, 0
  s_cbranch_scc1 F_pb1h_2
  s_getreg_b32 s65, hwreg(HW_REG_IB_STS)
  s_and_b32 s65, s65, 0xc0000f
  s_cmp_gt_u32 s65, 0
  s_cbranch_scc1 F_pb1h_2
  s_mov_b64 exec, 255
  buffer_store_dwordx2 v[30:31], v9, s[32:35], s6 offen sc1
  s_mov_b64 exec, -1
  s_mov_b32 s66, 1
F_pb1h_2:
  ds_read_b64_tr_b16 v[252:253], v16 offset:6144
  ds_read_b64_tr_b16 v[254:255], v16 offset:6656
  s_waitcnt lgkmcnt(10)
  v_mfma_f32_32x32x16_bf16 v[80:95], v[44:47], v[128:131], v[80:95]
  s_cmp_lg_u32 s66, 0
  s_cbranch_scc1 F_pb1h_3
  s_getreg_b32 s65, hwreg(HW_REG_IB_STS)
  s_and_b32 s65, s65, 0xc0000f
  s_cmp_gt_u32 s65, 0
  s_cbranch_scc1 F_pb1h_3
  s_mov_b64 exec, 255
  buffer_store_dwordx2 v[30:31], v9, s[32:35], s6 offen sc1
  s_mov_b64 exec, -1
  s_mov_b32 s66, 1
F_pb1h_3:
  ds_read_b64_tr_b16 v[44:45], v15 offset:8192
  ds_read_b64_tr_b16 v[46:47], v15 offset:8704
  s_waitcnt lgkmcnt(10)
  v_mfma_f32_32x32x16_bf16 v[64:79], v[48:51], v[128:131], v[64:79]
  s_cmp_lg_u32 s66, 0
  s_cbranch_scc1 F_pb1h_4
  s_getreg_b32 s65, hwreg(HW_REG_IB_STS)
  s_and_b32 s65, s65, 0xc0000f
  s_cmp_gt_u32 s65, 0
  s_cbranch_scc1 F_pb1h_4
  s_mov_b64 exec, 255
  buffer_store_dwordx2 v[30:31], v9, s[32:35], s6 offen sc1
  s_mov_b64 exec, -1
  s_mov_b32 s66, 1
F_pb1h_4:
  ds_read_b64_tr_b16 v[48:49], v16 offset:8192
  ds_read_b64_tr_b16 v[50:51], v16 offset:8704
  s_waitcnt lgkmcnt(10)
  v_mfma_f32_32x32x16_bf16 v[80:95], v[52:55], v[132:135], v[80:95]
  s_cmp_lg_u32 s66, 0
  s_cbranch_scc1 F_pb1h_5
  s_getreg_b32 s65, hwreg(HW_REG_IB_STS)
  s_and_b32 s65, s65, 0xc0000f
  s_cmp_gt_u32 s65, 0
  s_cbranch_scc1 F_pb1h_5
  s_mov_b64 exec, 255
  buffer_store_dwordx2 v[30:31], v9, s[32:35], s6 offen sc1
  s_mov_b64 exec, -1
  s_mov_b32 s66, 1
F_pb1h_5:
  ds_read_b64_tr_b16 v[52:53], v15 offset:10240
  ds_read_b64_tr_b16 v[54:55], v15 offset:10752
  s_waitcnt lgkmcnt(10)
  v_mfma_f32_32x32x16_bf16 v[64:79], v[56:59], v[132:135], v[64:79]
  s_cmp_lg_u32 s66, 0
  s_cbranch_scc1 F_pb1h_6
  s_getreg_b32 s65, hwreg(HW_REG_IB_STS)
  s_and_b32 s65, s65, 0xc0000f
  s_cmp_gt_u32 s65, 0
  s_cbranch_scc1 F_pb1h_6
  s_mov_b64 exec, 255
  buffer_store_dwordx2 v[30:31], v9, s[32:35], s6 offen sc1
  s_mov_b64 exec, -1
  s_mov_b32 s66, 1
F_pb1h_6:
  ds_read_b64_tr_b16 v[56:57], v16 offset:10240
  ds_read_b64_tr_b16 v[58:59], v16 offset:10752
  s_waitcnt lgkmcnt(10)
  v_mfma_f32_32x32x16_bf16 v[80:95], v[60:63], v[136:139], v[80:95]
  s_cmp_lg_u32 s66, 0
  s_cbranch_scc1 F_pb1h_7
  s_getreg_b32 s65, hwreg(HW_REG_IB_STS)
  s_and_b32 s65, s65, 0xc0000f
  s_cmp_gt_u32 s65, 0
  s_cbranch_scc1 F_pb1h_7
  s_mov_b64 exec, 255
  buffer_store_dwordx2 v[30:31], v9, s[32:35], s6 offen sc1
  s_mov_b64 exec, -1
  s_mov_b32 s66, 1
F_pb1h_7:
  ds_read_b64_tr_b16 v[60:61], v15 offset:12288
  ds_read_b64_tr_b16 v[62:63], v15 offset:12800
  s_waitcnt lgkmcnt(10)
  v_mfma_f32_32x32x16_bf16 v[64:79], v[252:255], v[136:139], v[64:79]
  s_cmp_lg_u32 s66, 0
  s_cbranch_scc1 F_pb1h_8
  s_getreg_b32 s65, hwreg(HW_REG_IB_STS)
  s_and_b32 s65, s65, 0xc0000f
  s_cmp_gt_u32 s65, 0
  s_cbranch_scc1 F_pb1h_8
  s_mov_b64 exec, 255
  buffer_store_dwordx2 v[30:31], v9, s[32:35], s6 offen sc1
  s_mov_b64 exec, -1
  s_mov_b32 s66, 1
F_pb1h_8:
  ds_read_b64_tr_b16 v[252:253], v16 offset:12288
  ds_read_b64_tr_b16 v[254:255], v16 offset:12800
  s_waitcnt lgkmcnt(10)
  v_mfma_f32_32x32x16_bf16 v[80:95], v[44:47], v[140:143], v[80:95]
  s_cmp_lg_u32 s66, 0
  s_cbranch_scc1 F_pb1h_9
  s_getreg_b32 s65, hwreg(HW_REG_IB_STS)
  s_and_b32 s65, s65, 0xc0000f
  s_cmp_gt_u32 s65, 0
  s_cbranch_scc1 F_pb1h_9
  s_mov_b64 exec, 255
  buffer_store_dwordx2 v[30:31], v9, s[32:35], s6 offen sc1
  s_mov_b64 exec, -1
  s_mov_b32 s66, 1
F_pb1h_9:
  ds_read_b64_tr_b16 v[44:45], v15 offset:14336
  ds_read_b64_tr_b16 v[46:47], v15 offset:14848
  s_waitcnt lgkmcnt(10)
  v_mfma_f32_32x32x16_bf16 v[64:79], v[48:51], v[140:143], v[64:79]
  s_cmp_lg_u32 s66, 0
  s_cbranch_scc1 F_pb1h_10
  s_getreg_b32 s65, hwreg(HW_REG_IB_STS)
  s_and_b32 s65, s65, 0xc0000f
  s_cmp_gt_u32 s65, 0
  s_cbranch_scc1 F_pb1h_10
  s_mov_b64 exec, 255
  buffer_store_dwordx2 v[30:31], v9, s[32:35], s6 offen sc1
  s_mov_b64 exec, -1
  s_mov_b32 s66, 1
F_pb1h_10:
  ds_read_b64_tr_b16 v[48:49], v16 offset:14336
  ds_read_b64_tr_b16 v[50:51], v16 offset:14848
  s_waitcnt lgkmcnt(10)
  v_mfma_f32_32x32x16_bf16 v[80:95], v[52:55], v[144:147], v[80:95]
  s_cmp_lg_u32 s66, 0
  s_cbranch_scc1 F_pb1h_11
  s_getreg_b32 s65, hwreg(HW_REG_IB_STS)
  s_and_b32 s65, s65, 0xc0000f
  s_cmp_gt_u32 s65, 0
  s_cbranch_scc1 F_pb1h_11
  s_mov_b64 exec, 255
  buffer_store_dwordx2 v[30:31], v9, s[32:35], s6 offen sc1
  s_mov_b64 exec, -1
  s_mov_b32 s66, 1
F_pb1h_11:
  ds_read_b64_tr_b16 v[52:53], v15 offset:16384
  ds_read_b64_tr_b16 v[54:55], v15 offset:16896
  s_waitcnt lgkmcnt(10)
  v_mfma_f32_32x32x16_bf16 v[64:79], v[56:59], v[144:147], v[64:79]
  s_cmp_lg_u32 s66, 0
  s_cbranch_scc1 F_pb1h_12
  s_getreg_b32 s65, hwreg(HW_REG_IB_STS)
  s_and_b32 s65, s65, 0xc0000f
  s_cmp_gt_u32 s65, 0
  s_cbranch_scc1 F_pb1h_12
  s_mov_b64 exec, 255
  buffer_store_dwordx2 v[30:31], v9, s[32:35], s6 offen sc1
  s_mov_b64 exec, -1
  s_mov_b32 s66, 1
F_pb1h_12:
  ds_read_b64_tr_b16 v[56:57], v16 offset:16384
  ds_read_b64_tr_b16 v[58:59], v16 offset:16896
  s_waitcnt lgkmcnt(10)
  v_mfma_f32_32x32x16_bf16 v[80:95], v[60:63], v[148:151], v[80:95]
  s_cmp_lg_u32 s66, 0
  s_cbranch_scc1 F_pb1h_13
  s_getreg_b32 s65, hwreg(HW_REG_IB_STS)
  s_and_b32 s65, s65, 0xc0000f
  s_cmp_gt_u32 s65, 0
  s_cbranch_scc1 F_pb1h_13
  s_mov_b64 exec, 255
  buffer_store_dwordx2 v[30:31], v9, s[32:35], s6 offen sc1
  s_mov_b64 exec, -1
  s_mov_b32 s66, 1
F_pb1h_13:
  ds_read_b64_tr_b16 v[60:61], v15 offset:18432
  ds_read_b64_tr_b16 v[62:63], v15 offset:18944
  s_waitcnt lgkmcnt(10)
  v_mfma_f32_32x32x16_bf16 v[64:79], v[252:255], v[148:151], v[64:79]
  s_cmp_lg_u32 s66, 0
  s_cbranch_scc1 F_pb1h_14
  s_getreg_b32 s65, hwreg(HW_REG_IB_STS)
  s_and_b32 s65, s65, 0xc0000f
  s_cmp_gt_u32 s65, 0
  s_cbranch_scc1 F_pb1h_14
  s_mov_b64 exec, 255
  buffer_store_dwordx2 v[30:31], v9, s[32:35], s6 offen sc1
  s_mov_b64 exec, -1
  s_mov_b32 s66, 1
F_pb1h_14:
  ds_read_b64_tr_b16 v[252:253], v16 offset:18432
  ds_read_b64_tr_b16 v[254:255], v16 offset:18944
  s_waitcnt lgkmcnt(10)
  v_mfma_f32_32x32x16_bf16 v[80:95], v[44:47], v[152:155], v[80:95]
  s_cmp_lg_u32 s66, 0
  s_cbranch_scc1 F_pb1h_15
  s_getreg_b32 s65, hwreg(HW_REG_IB_STS)
  s_and_b32 s65, s65, 0xc0000f
  s_cmp_gt_u32 s65, 0
  s_cbranch_scc1 F_pb1h_15
  s_mov_b64 exec, 255
  buffer_store_dwordx2 v[30:31], v9, s[32:35], s6 offen sc1
  s_mov_b64 exec, -1
  s_mov_b32 s66, 1
F_pb1h_15:
  ds_read_b64_tr_b16 v[44:45], v15 offset:20480
  ds_read_b64_tr_b16 v[46:47], v15 offset:20992
  s_waitcnt lgkmcnt(10)
  v_mfma_f32_32x32x16_bf16 v[64:79], v[48:51], v[152:155], v[64:79]
  s_cmp_lg_u32 s66, 0
  s_cbranch_scc1 F_pb1h_16
  s_getreg_b32 s65, hwreg(HW_REG_IB_STS)
  s_and_b32 s65, s65, 0xc0000f
  s_cmp_gt_u32 s65, 0
  s_cbranch_scc1 F_pb1h_16
  s_mov_b64 exec, 255
  buffer_store_dwordx2 v[30:31], v9, s[32:35], s6 offen sc1
  s_mov_b64 exec, -1
  s_mov_b32 s66, 1
F_pb1h_16:
  ds_read_b64_tr_b16 v[48:49], v16 offset:20480
  ds_read_b64_tr_b16 v[50:51], v16 offset:20992
  s_waitcnt lgkmcnt(10)
  v_mfma_f32_32x32x16_bf16 v[80:95], v[52:55], v[156:159], v[80:95]
  s_cmp_lg_u32 s66, 0
  s_cbranch_scc1 F_pb1h_17
  s_waitcnt vmcnt(0)
  s_mov_b64 exec, 255
  buffer_store_dwordx2 v[30:31], v9, s[32:35], s6 offen sc1
  s_mov_b64 exec, -1
  s_mov_b32 s66, 1
F_pb1h_17:
  ds_read_b64_tr_b16 v[52:53], v15 offset:22528
  ds_read_b64_tr_b16 v[54:55], v15 offset:23040
  s_waitcnt lgkmcnt(10)
  v_mfma_f32_32x32x16_bf16 v[64:79], v[56:59], v[156:159], v[64:79]
  ds_read_b64_tr_b16 v[56:57], v16 offset:22528
  ds_read_b64_tr_b16 v[58:59], v16 offset:23040
  s_waitcnt lgkmcnt(10)
  v_mfma_f32_32x32x16_bf16 v[80:95], v[60:63], v[160:163], v[80:95]
  ds_read_b64_tr_b16 v[60:61], v15 offset:24576
  ds_read_b64_tr_b16 v[62:63], v15 offset:25088
  s_waitcnt lgkmcnt(10)
  v_mfma_f32_32x32x16_bf16 v[64:79], v[252:255], v[160:163], v[64:79]
  ds_read_b64_tr_b16 v[252:253], v16 offset:24576
  ds_read_b64_tr_b16 v[254:255], v16 offset:25088
  s_waitcnt lgkmcnt(10)
  v_mfma_f32_32x32x16_bf16 v[80:95], v[44:47], v[164:167], v[80:95]
  ds_read_b64_tr_b16 v[44:45], v15 offset:26624
  ds_read_b64_tr_b16 v[46:47], v15 offset:27136
  s_waitcnt lgkmcnt(10)
  v_mfma_f32_32x32x16_bf16 v[64:79], v[48:51], v[164:167], v[64:79]
  ds_read_b64_tr_b16 v[48:49], v16 offset:26624
  ds_read_b64_tr_b16 v[50:51], v16 offset:27136
  s_waitcnt lgkmcnt(10)
  v_mfma_f32_32x32x16_bf16 v[80:95], v[52:55], v[168:171], v[80:95]
  ds_read_b64_tr_b16 v[52:53], v15 offset:28672
  ds_read_b64_tr_b16 v[54:55], v15 offset:29184
  s_waitcnt lgkmcnt(10)
  v_mfma_f32_32x32x16_bf16 v[64:79], v[56:59], v[168:171], v[64:79]
  ds_read_b64_tr_b16 v[56:57], v16 offset:28672
  ds_read_b64_tr_b16 v[58:59], v16 offset:29184
  s_waitcnt lgkmcnt(10)
  v_mfma_f32_32x32x16_bf16 v[80:95], v[60:63], v[172:175], v[80:95]
  s_lshl_b32 s70, s54, 3
  s_add_u32 s70, s70, s51
  s_lshl_b32 s70, s70, 5
  s_add_u32 s70, s70, s53
  s_lshl_b32 s70, s70, 10
  s_add_u32 s70, s70, 18874368
  s_add_u32 s71, s70, 131072
  v_mov_b32 v32, -1
  v_mov_b32 v33, -1
  v_mov_b32 v34, -1
  v_mov_b32 v35, -1
  buffer_store_dwordx4 v[32:35], v3, s[32:35], s70 offen sc1
  buffer_store_dwordx4 v[32:35], v3, s[32:35], s71 offen sc1
  ds_read_b64_tr_b16 v[60:61], v15 offset:30720
  ds_read_b64_tr_b16 v[62:63], v15 offset:31232
  s_waitcnt lgkmcnt(10)
  v_mfma_f32_32x32x16_bf16 v[64:79], v[252:255], v[172:175], v[64:79]
  ds_read_b64_tr_b16 v[252:253], v16 offset:30720
  ds_read_b64_tr_b16 v[254:255], v16 offset:31232
  s_waitcnt lgkmcnt(10)
  v_mfma_f32_32x32x16_bf16 v[80:95], v[44:47], v[176:179], v[80:95]
  ds_read_b64_tr_b16 v[44:45], v15 offset:32768
  ds_read_b64_tr_b16 v[46:47], v15 offset:33280
  s_waitcnt lgkmcnt(10)
  v_mfma_f32_32x32x16_bf16 v[64:79], v[48:51], v[176:179], v[64:79]
  ds_read_b64_tr_b16 v[48:49], v16 offset:32768
  ds_read_b64_tr_b16 v[50:51], v16 offset:33280
  s_waitcnt lgkmcnt(10)
  v_mfma_f32_32x32x16_bf16 v[80:95], v[52:55], v[180:183], v[80:95]
  ds_read_b64_tr_b16 v[52:53], v15 offset:34816
  ds_read_b64_tr_b16 v[54:55], v15 offset:35328
  s_waitcnt lgkmcnt(10)
  v_mfma_f32_32x32x16_bf16 v[64:79], v[56:59], v[180:183], v[64:79]
  ds_read_b64_tr_b16 v[56:57], v16 offset:34816
  ds_read_b64_tr_b16 v[58:59], v16 offset:35328
  s_waitcnt lgkmcnt(10)
  v_mfma_f32_32x32x16_bf16 v[80:95], v[60:63], v[184:187], v[80:95]
  ds_read_b64_tr_b16 v[60:61], v15 offset:36864
  ds_read_b64_tr_b16 v[62:63], v15 offset:37376
  s_waitcnt lgkmcnt(10)
  v_mfma_f32_32x32x16_bf16 v[64:79], v[252:255], v[184:187], v[64:79]
  ds_read_b64_tr_b16 v[252:253], v16 offset:36864
  ds_read_b64_tr_b16 v[254:255], v16 offset:37376
  s_waitcnt lgkmcnt(10)
  v_mfma_f32_32x32x16_bf16 v[80:95], v[44:47], v[188:191], v[80:95]
  ds_read_b64_tr_b16 v[44:45], v15 offset:38912
  ds_read_b64_tr_b16 v[46:47], v15 offset:39424
  s_waitcnt lgkmcnt(10)
  v_mfma_f32_32x32x16_bf16 v[64:79], v[48:51], v[188:191], v[64:79]
  ds_read_b64_tr_b16 v[48:49], v16 offset:38912
  ds_read_b64_tr_b16 v[50:51], v16 offset:39424
  s_waitcnt lgkmcnt(10)
  v_mfma_f32_32x32x16_bf16 v[80:95], v[52:55], v[192:195], v[80:95]
  ds_read_b64_tr_b16 v[52:53], v15 offset:40960
  ds_read_b64_tr_b16 v[54:55], v15 offset:41472
  s_waitcnt lgkmcnt(10)
  v_mfma_f32_32x32x16_bf16 v[64:79], v[56:59], v[192:195], v[64:79]
  ds_read_b64_tr_b16 v[56:57], v15 offset:43008
  ds_read_b64_tr_b16 v[58:59], v15 offset:43520
  s_waitcnt lgkmcnt(10)
  v_mfma_f32_32x32x16_bf16 v[80:95], v[60:63], v[196:199], v[80:95]
  ds_read_b64_tr_b16 v[60:61], v15 offset:45056
  ds_read_b64_tr_b16 v[62:63], v15 offset:45568
  s_waitcnt lgkmcnt(10)
  v_mfma_f32_32x32x16_bf16 v[64:79], v[252:255], v[196:199], v[64:79]
  ds_read_b64_tr_b16 v[252:253], v15 offset:47104
  ds_read_b64_tr_b16 v[254:255], v15 offset:47616
  s_waitcnt lgkmcnt(10)
  v_mfma_f32_32x32x16_bf16 v[80:95], v[44:47], v[200:203], v[80:95]
  ds_read_b64_tr_b16 v[44:45], v17 offset:0
  ds_read_b64_tr_b16 v[46:47], v17 offset:512
  s_waitcnt lgkmcnt(10)
  v_mfma_f32_32x32x16_bf16 v[64:79], v[48:51], v[200:203], v[64:79]
  ds_read_b64_tr_b16 v[48:49], v17 offset:2048
  ds_read_b64_tr_b16 v[50:51], v17 offset:2560
  s_waitcnt lgkmcnt(10)
  v_mfma_f32_32x32x16_bf16 v[80:95], v[52:55], v[204:207], v[80:95]
  ds_read_b64_tr_b16 v[52:53], v17 offset:4096
  ds_read_b64_tr_b16 v[54:55], v17 offset:4608
  s_waitcnt lgkmcnt(10)
  v_mfma_f32_32x32x16_bf16 v[80:95], v[56:59], v[208:211], v[80:95]
  ds_read_b64_tr_b16 v[56:57], v17 offset:6144
  ds_read_b64_tr_b16 v[58:59], v17 offset:6656
  s_waitcnt lgkmcnt(10)
  v_mfma_f32_32x32x16_bf16 v[80:95], v[60:63], v[212:215], v[80:95]
  ds_read_b64_tr_b16 v[60:61], v17 offset:8192
  ds_read_b64_tr_b16 v[62:63], v17 offset:8704
  s_waitcnt lgkmcnt(10)
  v_mfma_f32_32x32x16_bf16 v[80:95], v[252:255], v[216:219], v[80:95]
  ds_read_b64_tr_b16 v[252:253], v17 offset:10240
  ds_read_b64_tr_b16 v[254:255], v17 offset:10752
  s_waitcnt lgkmcnt(10)
  v_mfma_f32_32x32x16_bf16 v[80:95], v[44:47], v[220:223], v[80:95]
  ds_read_b64_tr_b16 v[44:45], v17 offset:12288
  ds_read_b64_tr_b16 v[46:47], v17 offset:12800
  s_waitcnt lgkmcnt(10)
  v_mfma_f32_32x32x16_bf16 v[80:95], v[48:51], v[224:227], v[80:95]
  ds_read_b64_tr_b16 v[48:49], v17 offset:14336
  ds_read_b64_tr_b16 v[50:51], v17 offset:14848
  s_waitcnt lgkmcnt(10)
  v_mfma_f32_32x32x16_bf16 v[80:95], v[52:55], v[228:231], v[80:95]
  ds_read_b64_tr_b16 v[52:53], v16 offset:40960
  ds_read_b64_tr_b16 v[54:55], v16 offset:41472
  s_waitcnt lgkmcnt(10)
  v_mfma_f32_32x32x16_bf16 v[80:95], v[56:59], v[232:235], v[80:95]
  ds_read_b64_tr_b16 v[56:57], v16 offset:43008
  ds_read_b64_tr_b16 v[58:59], v16 offset:43520
  s_waitcnt lgkmcnt(10)
  v_mfma_f32_32x32x16_bf16 v[80:95], v[60:63], v[236:239], v[80:95]
  ds_read_b64_tr_b16 v[60:61], v16 offset:45056
  ds_read_b64_tr_b16 v[62:63], v16 offset:45568
  s_waitcnt lgkmcnt(10)
  v_mfma_f32_32x32x16_bf16 v[80:95], v[252:255], v[240:243], v[80:95]
  ds_read_b64_tr_b16 v[252:253], v16 offset:47104
  ds_read_b64_tr_b16 v[254:255], v16 offset:47616
  s_waitcnt lgkmcnt(10)
  v_mfma_f32_32x32x16_bf16 v[80:95], v[44:47], v[244:247], v[80:95]
  ds_read_b64_tr_b16 v[44:45], v18 offset:0
  ds_read_b64_tr_b16 v[46:47], v18 offset:512
  s_waitcnt lgkmcnt(10)
  v_mfma_f32_32x32x16_bf16 v[80:95], v[48:51], v[248:251], v[80:95]
  ds_read_b64_tr_b16 v[48:49], v18 offset:2048
  ds_read_b64_tr_b16 v[50:51], v18 offset:2560
  s_nop 11
  v_mul_f32 v100, s76, v80
  v_mul_f32 v101, s76, v81
  v_mul_f32 v102, s76, v82
  v_mul_f32 v103, s76, v83
  v_mul_f32 v104, s76, v84
  v_mul_f32 v105, s76, v85
  v_mul_f32 v106, s76, v86
  v_mul_f32 v107, s76, v87
  s_waitcnt lgkmcnt(10)
  v_mfma_f32_32x32x16_bf16 v[64:79], v[52:55], v[204:207], v[64:79]
  ds_read_b64_tr_b16 v[52:53], v18 offset:4096
  ds_read_b64_tr_b16 v[54:55], v18 offset:4608
  s_nop 8
  v_mul_f32 v108, s76, v88
  v_mul_f32 v109, s76, v89
  v_mul_f32 v110, s76, v90
  v_mul_f32 v111, s76, v91
  v_mul_f32 v112, s76, v92
  v_mul_f32 v113, s76, v93
  v_mul_f32 v114, s76, v94
  v_mul_f32 v115, s76, v95
  v_exp_f32 v100, v100
  v_exp_f32 v101, v101
  v_exp_f32 v102, v102
  s_waitcnt lgkmcnt(10)
  v_mfma_f32_32x32x16_bf16 v[64:79], v[56:59], v[208:211], v[64:79]
  ds_read_b64_tr_b16 v[56:57], v18 offset:6144
  ds_read_b64_tr_b16 v[58:59], v18 offset:6656
  v_exp_f32 v108, v108
  v_exp_f32 v109, v109
  v_exp_f32 v110, v110
  v_exp_f32 v103, v103
  v_exp_f32 v104, v104
  v_exp_f32 v105, v105
  s_waitcnt lgkmcnt(10)
  v_mfma_f32_32x32x16_bf16 v[64:79], v[60:63], v[212:215], v[64:79]
  ds_read_b64_tr_b16 v[60:61], v18 offset:8192
  ds_read_b64_tr_b16 v[62:63], v18 offset:8704
  v_exp_f32 v111, v111
  v_exp_f32 v112, v112
  v_exp_f32 v113, v113
  v_exp_f32 v106, v106
  v_exp_f32 v107, v107
  s_waitcnt lgkmcnt(10)
  v_mfma_f32_32x32x16_bf16 v[64:79], v[252:255], v[216:219], v[64:79]
  ds_read_b64_tr_b16 v[252:253], v18 offset:10240
  ds_read_b64_tr_b16 v[254:255], v18 offset:10752
  v_exp_f32 v114, v114
  v_exp_f32 v115, v115
  v_add_f32 v100, 1.0, v100
  v_add_f32 v101, 1.0, v101
  v_add_f32 v102, 1.0, v102
  v_add_f32 v103, 1.0, v103
  v_add_f32 v104, 1.0, v104
  v_add_f32 v105, 1.0, v105
  v_add_f32 v106, 1.0, v106
  v_add_f32 v107, 1.0, v107
  s_waitcnt lgkmcnt(10)
  v_mfma_f32_32x32x16_bf16 v[64:79], v[44:47], v[220:223], v[64:79]
  ds_read_b64_tr_b16 v[44:45], v18 offset:12288
  ds_read_b64_tr_b16 v[46:47], v18 offset:12800
  v_add_f32 v108, 1.0, v108
  v_add_f32 v109, 1.0, v109
  v_add_f32 v110, 1.0, v110
  v_add_f32 v111, 1.0, v111
  v_add_f32 v112, 1.0, v112
  v_add_f32 v113, 1.0, v113
  v_add_f32 v114, 1.0, v114
  v_add_f32 v115, 1.0, v115
  v_rcp_f32 v100, v100
  v_rcp_f32 v101, v101
  v_rcp_f32 v102, v102
  s_waitcnt lgkmcnt(10)
  v_mfma_f32_32x32x16_bf16 v[64:79], v[48:51], v[224:227], v[64:79]
  ds_read_b64_tr_b16 v[48:49], v18 offset:14336
  ds_read_b64_tr_b16 v[50:51], v18 offset:14848
  v_rcp_f32 v108, v108
  v_rcp_f32 v109, v109
  v_rcp_f32 v110, v110
  v_rcp_f32 v103, v103
  v_rcp_f32 v104, v104
  v_rcp_f32 v105, v105
  s_waitcnt lgkmcnt(10)
  v_mfma_f32_32x32x16_bf16 v[64:79], v[52:55], v[228:231], v[64:79]
  v_rcp_f32 v111, v111
  v_rcp_f32 v112, v112
  v_rcp_f32 v113, v113
  v_rcp_f32 v106, v106
  v_rcp_f32 v107, v107
  s_waitcnt lgkmcnt(8)
  v_mfma_f32_32x32x16_bf16 v[64:79], v[56:59], v[232:235], v[64:79]
  v_rcp_f32 v114, v114
  v_rcp_f32 v115, v115
  v_mul_f32 v100, v80, v100
  v_mul_f32 v101, v81, v101
  v_mul_f32 v102, v82, v102
  v_mul_f32 v103, v83, v103
  v_mul_f32 v104, v84, v104
  v_mul_f32 v105, v85, v105
  v_mul_f32 v106, v86, v106
  v_mul_f32 v107, v87, v107
  s_waitcnt lgkmcnt(6)
  v_mfma_f32_32x32x16_bf16 v[64:79], v[60:63], v[236:239], v[64:79]
  v_mul_f32 v108, v88, v108
  v_mul_f32 v109, v89, v109
  v_mul_f32 v110, v90, v110
  v_mul_f32 v111, v91, v111
  v_mul_f32 v112, v92, v112
  v_mul_f32 v113, v93, v113
  v_mul_f32 v114, v94, v114
  v_mul_f32 v115, v95, v115
  v_cvt_pk_bf16_f32 v140, v100, v101
  v_cvt_pk_bf16_f32 v141, v102, v103
  v_cvt_pk_bf16_f32 v142, v104, v105
  v_cvt_pk_bf16_f32 v143, v106, v107
  s_waitcnt lgkmcnt(4)
  v_mfma_f32_32x32x16_bf16 v[64:79], v[252:255], v[240:243], v[64:79]
  v_cvt_pk_bf16_f32 v144, v108, v109
  v_cvt_pk_bf16_f32 v145, v110, v111
  v_cvt_pk_bf16_f32 v146, v112, v113
  v_cvt_pk_bf16_f32 v147, v114, v115
  s_waitcnt lgkmcnt(2)
  v_mfma_f32_32x32x16_bf16 v[64:79], v[44:47], v[244:247], v[64:79]
  v_add_u32 v4, 4096, v3
  v_mov_b32 v5, v3
  s_mov_b64 exec, 0x1fff
  ds_write_b128 v8, v[116:119]
  s_mov_b64 exec, -1
  s_waitcnt lgkmcnt(0)
  v_mfma_f32_32x32x16_bf16 v[64:79], v[48:51], v[248:251], v[64:79]
  s_nop 11
  v_pk_mul_f32 v[100:101], v[64:65], s[76:77] op_sel_hi:[1,0]
  v_pk_mul_f32 v[102:103], v[66:67], s[76:77] op_sel_hi:[1,0]
  v_pk_mul_f32 v[104:105], v[68:69], s[76:77] op_sel_hi:[1,0]
  v_pk_mul_f32 v[106:107], v[70:71], s[76:77] op_sel_hi:[1,0]
  s_nop 11
  v_pk_mul_f32 v[108:109], v[72:73], s[76:77] op_sel_hi:[1,0]
  v_pk_mul_f32 v[110:111], v[74:75], s[76:77] op_sel_hi:[1,0]
  v_pk_mul_f32 v[112:113], v[76:77], s[76:77] op_sel_hi:[1,0]
  v_pk_mul_f32 v[114:115], v[78:79], s[76:77] op_sel_hi:[1,0]
  v_exp_f32 v100, v100
  v_exp_f32 v101, v101
  v_exp_f32 v102, v102
  v_exp_f32 v108, v108
  v_exp_f32 v109, v109
  v_exp_f32 v110, v110
  v_exp_f32 v103, v103
  v_exp_f32 v104, v104
  v_exp_f32 v105, v105
  v_exp_f32 v111, v111
  v_exp_f32 v112, v112
  v_exp_f32 v113, v113
  v_exp_f32 v106, v106
  v_exp_f32 v107, v107
  v_exp_f32 v114, v114
  v_exp_f32 v115, v115
  v_pk_add_f32 v[100:101], v[100:101], 1.0 op_sel_hi:[1,0]
  v_pk_add_f32 v[102:103], v[102:103], 1.0 op_sel_hi:[1,0]
  v_pk_add_f32 v[104:105], v[104:105], 1.0 op_sel_hi:[1,0]
  v_pk_add_f32 v[106:107], v[106:107], 1.0 op_sel_hi:[1,0]
  v_pk_add_f32 v[108:109], v[108:109], 1.0 op_sel_hi:[1,0]
  v_pk_add_f32 v[110:111], v[110:111], 1.0 op_sel_hi:[1,0]
  v_pk_add_f32 v[112:113], v[112:113], 1.0 op_sel_hi:[1,0]
  v_pk_add_f32 v[114:115], v[114:115], 1.0 op_sel_hi:[1,0]
  v_rcp_f32 v100, v100
  v_rcp_f32 v101, v101
  v_rcp_f32 v102, v102
  v_rcp_f32 v108, v108
  v_rcp_f32 v109, v109
  v_rcp_f32 v110, v110
  v_rcp_f32 v103, v103
  v_rcp_f32 v104, v104
  v_rcp_f32 v105, v105
  v_rcp_f32 v111, v111
  v_rcp_f32 v112, v112
  v_rcp_f32 v113, v113
  v_rcp_f32 v106, v106
  v_rcp_f32 v107, v107
  v_rcp_f32 v114, v114
  v_rcp_f32 v115, v115
  s_nop 0
  v_pk_mul_f32 v[100:101], v[64:65], v[100:101]
  v_pk_mul_f32 v[102:103], v[66:67], v[102:103]
  v_pk_mul_f32 v[104:105], v[68:69], v[104:105]
  v_pk_mul_f32 v[106:107], v[70:71], v[106:107]
  s_nop 0
  v_pk_mul_f32 v[108:109], v[72:73], v[108:109]
  v_pk_mul_f32 v[110:111], v[74:75], v[110:111]
  v_pk_mul_f32 v[112:113], v[76:77], v[112:113]
  v_pk_mul_f32 v[114:115], v[78:79], v[114:115]
  v_cvt_pk_bf16_f32 v148, v100, v101
  v_cvt_pk_bf16_f32 v149, v102, v103
  v_cvt_pk_bf16_f32 v150, v104, v105
  v_cvt_pk_bf16_f32 v151, v106, v107
  v_cvt_pk_bf16_f32 v152, v108, v109
  v_cvt_pk_bf16_f32 v153, v110, v111
  v_cvt_pk_bf16_f32 v154, v112, v113
  v_cvt_pk_bf16_f32 v155, v114, v115
  s_setprio 0
  s_waitcnt lgkmcnt(0)
  s_branch F_attn
F_light:
  s_barrier
  ds_read_b64_tr_b16 v[60:61], v15 offset:0
  ds_read_b64_tr_b16 v[62:63], v15 offset:512
  ds_read_b64_tr_b16 v[252:253], v15 offset:2048
  ds_read_b64_tr_b16 v[254:255], v15 offset:2560
  ds_read_b64_tr_b16 v[44:45], v15 offset:4096
  ds_read_b64_tr_b16 v[46:47], v15 offset:4608
  ds_read_b64_tr_b16 v[48:49], v15 offset:6144
  ds_read_b64_tr_b16 v[50:51], v15 offset:6656
  ds_read_b64_tr_b16 v[52:53], v15 offset:8192
  ds_read_b64_tr_b16 v[54:55], v15 offset:8704
  ds_read_b64_tr_b16 v[56:57], v15 offset:10240
  ds_read_b64_tr_b16 v[58:59], v15 offset:10752
  s_waitcnt lgkmcnt(10)
  v_mfma_f32_32x32x16_bf16 v[80:95], v[60:63], v[124:127], 0
  s_mov_b32 s66, 0
  s_getreg_b32 s65, hwreg(HW_REG_IB_STS)
  s_and_b32 s65, s65, 0xc0000f
  s_cmp_gt_u32 s65, 0
  s_cbranch_scc1 F_pb1l_1
  s_mov_b64 exec, 255
  buffer_store_dwordx2 v[30:31], v9, s[32:35], s6 offen sc1
  s_mov_b64 exec, -1
  s_mov_b32 s66, 1
F_pb1l_1:
  ds_read_b64_tr_b16 v[60:61], v15 offset:12288
  ds_read_b64_tr_b16 v[62:63], v15 offset:12800
  s_setprio 1
  s_waitcnt lgkmcnt(10)
  v_mfma_f32_32x32x16_bf16 v[80:95], v[252:255], v[128:131], v[80:95]
  s_cmp_lg_u32 s66, 0
  s_cbranch_scc1 F_pb1l_2
  s_getreg_b32 s65, hwreg(HW_REG_IB_STS)
  s_and_b32 s65, s65, 0xc0000f
  s_cmp_gt_u32 s65, 0
  s_cbranch_scc1 F_pb1l_2
  s_mov_b64 exec, 255
  buffer_store_dwordx2 v[30:31], v9, s[32:35], s6 offen sc1
  s_mov_b64 exec, -1
  s_mov_b32 s66, 1
F_pb1l_2:
  ds_read_b64_tr_b16 v[252:253], v15 offset:14336
  ds_read_b64_tr_b16 v[254:255], v15 offset:14848
  s_waitcnt lgkmcnt(10)
  v_mfma_f32_32x32x16_bf16 v[80:95], v[44:47], v[132:135], v[80:95]
  s_cmp_lg_u32 s66, 0
  s_cbranch_scc1 F_pb1l_3
  s_getreg_b32 s65, hwreg(HW_REG_IB_STS)
  s_and_b32 s65, s65, 0xc0000f
  s_cmp_gt_u32 s65, 0
  s_cbranch_scc1 F_pb1l_3
  s_mov_b64 exec, 255
  buffer_store_dwordx2 v[30:31], v9, s[32:35], s6 offen sc1
  s_mov_b64 exec, -1
  s_mov_b32 s66, 1
F_pb1l_3:
  ds_read_b64_tr_b16 v[44:45], v15 offset:16384
  ds_read_b64_tr_b16 v[46:47], v15 offset:16896
  s_waitcnt lgkmcnt(10)
  v_mfma_f32_32x32x16_bf16 v[80:95], v[48:51], v[136:139], v[80:95]
  s_cmp_lg_u32 s66, 0
  s_cbranch_scc1 F_pb1l_4
  s_getreg_b32 s65, hwreg(HW_REG_IB_STS)
  s_and_b32 s65, s65, 0xc0000f
  s_cmp_gt_u32 s65, 0
  s_cbranch_scc1 F_pb1l_4
  s_mov_b64 exec, 255
  buffer_store_dwordx2 v[30:31], v9, s[32:35], s6 offen sc1
  s_mov_b64 exec, -1
  s_mov_b32 s66, 1
F_pb1l_4:
  ds_read_b64_tr_b16 v[48:49], v15 offset:18432
  ds_read_b64_tr_b16 v[50:51], v15 offset:18944
  s_waitcnt lgkmcnt(10)
  v_mfma_f32_32x32x16_bf16 v[80:95], v[52:55], v[140:143], v[80:95]
  s_cmp_lg_u32 s66, 0
  s_cbranch_scc1 F_pb1l_5
  s_getreg_b32 s65, hwreg(HW_REG_IB_STS)
  s_and_b32 s65, s65, 0xc0000f
  s_cmp_gt_u32 s65, 0
  s_cbranch_scc1 F_pb1l_5
  s_mov_b64 exec, 255
  buffer_store_dwordx2 v[30:31], v9, s[32:35], s6 offen sc1
  s_mov_b64 exec, -1
  s_mov_b32 s66, 1
F_pb1l_5:
  ds_read_b64_tr_b16 v[52:53], v15 offset:20480
  ds_read_b64_tr_b16 v[54:55], v15 offset:20992
  s_waitcnt lgkmcnt(10)
  v_mfma_f32_32x32x16_bf16 v[80:95], v[56:59], v[144:147], v[80:95]
  s_cmp_lg_u32 s66, 0
  s_cbranch_scc1 F_pb1l_6
  s_getreg_b32 s65, hwreg(HW_REG_IB_STS)
  s_and_b32 s65, s65, 0xc0000f
  s_cmp_gt_u32 s65, 0
  s_cbranch_scc1 F_pb1l_6
  s_mov_b64 exec, 255
  buffer_store_dwordx2 v[30:31], v9, s[32:35], s6 offen sc1
  s_mov_b64 exec, -1
  s_mov_b32 s66, 1
F_pb1l_6:
  ds_read_b64_tr_b16 v[56:57], v15 offset:22528
  ds_read_b64_tr_b16 v[58:59], v15 offset:23040
  s_waitcnt lgkmcnt(10)
  v_mfma_f32_32x32x16_bf16 v[80:95], v[60:63], v[148:151], v[80:95]
  s_cmp_lg_u32 s66, 0
  s_cbranch_scc1 F_pb1l_7
  s_getreg_b32 s65, hwreg(HW_REG_IB_STS)
  s_and_b32 s65, s65, 0xc0000f
  s_cmp_gt_u32 s65, 0
  s_cbranch_scc1 F_pb1l_7
  s_mov_b64 exec, 255
  buffer_store_dwordx2 v[30:31], v9, s[32:35], s6 offen sc1
  s_mov_b64 exec, -1
  s_mov_b32 s66, 1
F_pb1l_7:
  ds_read_b64_tr_b16 v[60:61], v15 offset:24576
  ds_read_b64_tr_b16 v[62:63], v15 offset:25088
  s_waitcnt lgkmcnt(10)
  v_mfma_f32_32x32x16_bf16 v[80:95], v[252:255], v[152:155], v[80:95]
  s_cmp_lg_u32 s66, 0
  s_cbranch_scc1 F_pb1l_8
  s_getreg_b32 s65, hwreg(HW_REG_IB_STS)
  s_and_b32 s65, s65, 0xc0000f
  s_cmp_gt_u32 s65, 0
  s_cbranch_scc1 F_pb1l_8
  s_mov_b64 exec, 255
  buffer_store_dwordx2 v[30:31], v9, s[32:35], s6 offen sc1
  s_mov_b64 exec, -1
  s_mov_b32 s66, 1
F_pb1l_8:
  ds_read_b64_tr_b16 v[252:253], v15 offset:26624
  ds_read_b64_tr_b16 v[254:255], v15 offset:27136
  s_waitcnt lgkmcnt(10)
  v_mfma_f32_32x32x16_bf16 v[80:95], v[44:47], v[156:159], v[80:95]
  s_cmp_lg_u32 s66, 0
  s_cbranch_scc1 F_pb1l_9
  s_getreg_b32 s65, hwreg(HW_REG_IB_STS)
  s_and_b32 s65, s65, 0xc0000f
  s_cmp_gt_u32 s65, 0
  s_cbranch_scc1 F_pb1l_9
  s_mov_b64 exec, 255
  buffer_store_dwordx2 v[30:31], v9, s[32:35], s6 offen sc1
  s_mov_b64 exec, -1
  s_mov_b32 s66, 1
F_pb1l_9:
  ds_read_b64_tr_b16 v[44:45], v15 offset:28672
  ds_read_b64_tr_b16 v[46:47], v15 offset:29184
  s_waitcnt lgkmcnt(10)
  v_mfma_f32_32x32x16_bf16 v[80:95], v[48:51], v[160:163], v[80:95]
  s_cmp_lg_u32 s66, 0
  s_cbranch_scc1 F_pb1l_10
  s_getreg_b32 s65, hwreg(HW_REG_IB_STS)
  s_and_b32 s65, s65, 0xc0000f
  s_cmp_gt_u32 s65, 0
  s_cbranch_scc1 F_pb1l_10
  s_mov_b64 exec, 255
  buffer_store_dwordx2 v[30:31], v9, s[32:35], s6 offen sc1
  s_mov_b64 exec, -1
  s_mov_b32 s66, 1
F_pb1l_10:
  ds_read_b64_tr_b16 v[48:49], v15 offset:30720
  ds_read_b64_tr_b16 v[50:51], v15 offset:31232
  s_waitcnt lgkmcnt(10)
  v_mfma_f32_32x32x16_bf16 v[80:95], v[52:55], v[164:167], v[80:95]
  s_cmp_lg_u32 s66, 0
  s_cbranch_scc1 F_pb1l_11
  s_getreg_b32 s65, hwreg(HW_REG_IB_STS)
  s_and_b32 s65, s65, 0xc0000f
  s_cmp_gt_u32 s65, 0
  s_cbranch_scc1 F_pb1l_11
  s_mov_b64 exec, 255
  buffer_store_dwordx2 v[30:31], v9, s[32:35], s6 offen sc1
  s_mov_b64 exec, -1
  s_mov_b32 s66, 1
F_pb1l_11:
  ds_read_b64_tr_b16 v[52:53], v15 offset:32768
  ds_read_b64_tr_b16 v[54:55], v15 offset:33280
  s_waitcnt lgkmcnt(10)
  v_mfma_f32_32x32x16_bf16 v[80:95], v[56:59], v[168:171], v[80:95]
  s_cmp_lg_u32 s66, 0
  s_cbranch_scc1 F_pb1l_12
  s_getreg_b32 s65, hwreg(HW_REG_IB_STS)
  s_and_b32 s65, s65, 0xc0000f
  s_cmp_gt_u32 s65, 0
  s_cbranch_scc1 F_pb1l_12
  s_mov_b64 exec, 255
  buffer_store_dwordx2 v[30:31], v9, s[32:35], s6 offen sc1
  s_mov_b64 exec, -1
  s_mov_b32 s66, 1
F_pb1l_12:
  ds_read_b64_tr_b16 v[56:57], v15 offset:34816
  ds_read_b64_tr_b16 v[58:59], v15 offset:35328
  s_waitcnt lgkmcnt(10)
  v_mfma_f32_32x32x16_bf16 v[80:95], v[60:63], v[172:175], v[80:95]
  s_cmp_lg_u32 s66, 0
  s_cbranch_scc1 F_pb1l_13
  s_waitcnt vmcnt(0)
  s_mov_b64 exec, 255
  buffer_store_dwordx2 v[30:31], v9, s[32:35], s6 offen sc1
  s_mov_b64 exec, -1
  s_mov_b32 s66, 1
F_pb1l_13:
  ds_read_b64_tr_b16 v[60:61], v15 offset:36864
  ds_read_b64_tr_b16 v[62:63], v15 offset:37376
  s_waitcnt lgkmcnt(10)
  v_mfma_f32_32x32x16_bf16 v[80:95], v[252:255], v[176:179], v[80:95]
  ds_read_b64_tr_b16 v[252:253], v15 offset:38912
  ds_read_b64_tr_b16 v[254:255], v15 offset:39424
  s_waitcnt lgkmcnt(10)
  v_mfma_f32_32x32x16_bf16 v[80:95], v[44:47], v[180:183], v[80:95]
  ds_read_b64_tr_b16 v[44:45], v15 offset:40960
  ds_read_b64_tr_b16 v[46:47], v15 offset:41472
  s_waitcnt lgkmcnt(10)
  v_mfma_f32_32x32x16_bf16 v[80:95], v[48:51], v[184:187], v[80:95]
  ds_read_b64_tr_b16 v[48:49], v15 offset:43008
  ds_read_b64_tr_b16 v[50:51], v15 offset:43520
  s_waitcnt lgkmcnt(10)
  v_mfma_f32_32x32x16_bf16 v[80:95], v[52:55], v[188:191], v[80:95]
  ds_read_b64_tr_b16 v[52:53], v15 offset:45056
  ds_read_b64_tr_b16 v[54:55], v15 offset:45568
  s_waitcnt lgkmcnt(10)
  v_mfma_f32_32x32x16_bf16 v[80:95], v[56:59], v[192:195], v[80:95]
  ds_read_b64_tr_b16 v[56:57], v15 offset:47104
  ds_read_b64_tr_b16 v[58:59], v15 offset:47616
  s_waitcnt lgkmcnt(10)
  v_mfma_f32_32x32x16_bf16 v[80:95], v[60:63], v[196:199], v[80:95]
  ds_read_b64_tr_b16 v[60:61], v17 offset:0
  ds_read_b64_tr_b16 v[62:63], v17 offset:512
  s_waitcnt lgkmcnt(10)
  v_mfma_f32_32x32x16_bf16 v[80:95], v[252:255], v[200:203], v[80:95]
  ds_read_b64_tr_b16 v[252:253], v17 offset:2048
  ds_read_b64_tr_b16 v[254:255], v17 offset:2560
  s_waitcnt lgkmcnt(10)
  v_mfma_f32_32x32x16_bf16 v[80:95], v[44:47], v[204:207], v[80:95]
  s_lshl_b32 s70, s54, 3
  s_add_u32 s70, s70, s51
  s_lshl_b32 s70, s70, 5
  s_add_u32 s70, s70, s53
  s_lshl_b32 s70, s70, 10
  s_add_u32 s70, s70, 18874368
  s_add_u32 s71, s70, 131072
  v_mov_b32 v32, -1
  v_mov_b32 v33, -1
  v_mov_b32 v34, -1
  v_mov_b32 v35, -1
  buffer_store_dwordx4 v[32:35], v3, s[32:35], s70 offen sc1
  buffer_store_dwordx4 v[32:35], v3, s[32:35], s71 offen sc1
  ds_read_b64_tr_b16 v[44:45], v17 offset:4096
  ds_read_b64_tr_b16 v[46:47], v17 offset:4608
  s_waitcnt lgkmcnt(10)
  v_mfma_f32_32x32x16_bf16 v[80:95], v[48:51], v[208:211], v[80:95]
  ds_read_b64_tr_b16 v[48:49], v17 offset:6144
  ds_read_b64_tr_b16 v[50:51], v17 offset:6656
  s_waitcnt lgkmcnt(10)
  v_mfma_f32_32x32x16_bf16 v[80:95], v[52:55], v[212:215], v[80:95]
  ds_read_b64_tr_b16 v[52:53], v17 offset:8192
  ds_read_b64_tr_b16 v[54:55], v17 offset:8704
  s_waitcnt lgkmcnt(10)
  v_mfma_f32_32x32x16_bf16 v[80:95], v[56:59], v[216:219], v[80:95]
  ds_read_b64_tr_b16 v[56:57], v17 offset:10240
  ds_read_b64_tr_b16 v[58:59], v17 offset:10752
  s_waitcnt lgkmcnt(10)
  v_mfma_f32_32x32x16_bf16 v[80:95], v[60:63], v[220:223], v[80:95]
  ds_read_b64_tr_b16 v[60:61], v17 offset:12288
  ds_read_b64_tr_b16 v[62:63], v17 offset:12800
  s_waitcnt lgkmcnt(10)
  v_mfma_f32_32x32x16_bf16 v[80:95], v[252:255], v[224:227], v[80:95]
  ds_read_b64_tr_b16 v[252:253], v17 offset:14336
  ds_read_b64_tr_b16 v[254:255], v17 offset:14848
  s_waitcnt lgkmcnt(10)
  v_mfma_f32_32x32x16_bf16 v[80:95], v[44:47], v[228:231], v[80:95]
  s_waitcnt lgkmcnt(8)
  v_mfma_f32_32x32x16_bf16 v[80:95], v[48:51], v[232:235], v[80:95]
  s_waitcnt lgkmcnt(6)
  v_mfma_f32_32x32x16_bf16 v[80:95], v[52:55], v[236:239], v[80:95]
  s_waitcnt lgkmcnt(4)
  v_mfma_f32_32x32x16_bf16 v[80:95], v[56:59], v[240:243], v[80:95]
  s_waitcnt lgkmcnt(2)
  v_mfma_f32_32x32x16_bf16 v[80:95], v[60:63], v[244:247], v[80:95]
  v_add_u32 v4, 4096, v3
  v_mov_b32 v5, v3
  s_mov_b64 exec, 0x1fff
  ds_write_b128 v8, v[116:119]
  s_mov_b64 exec, -1
  s_waitcnt lgkmcnt(0)
  v_mfma_f32_32x32x16_bf16 v[80:95], v[252:255], v[248:251], v[80:95]
  s_lshl_b32 s61, s51, 2
  s_add_u32 s61, s61, 1
  s_cmp_eq_u32 s50, s61
  s_cbranch_scc0 F_nogate
  v_lshrrev_b32 v26, 5, v2
  v_lshlrev_b32 v26, 4, v26
  v_add_u32 v26, 143360, v26
  v_mov_b32 v28, 0
  v_mov_b32 v29, 0
  s_add_u32 s61, s52, 0
  s_and_b32 s61, s61, 7
  s_lshl_b32 s61, s61, 7
  v_add_u32 v27, s61, v26
  ds_read_b128 v[100:103], v27 offset:0
  ds_read_b128 v[104:107], v27 offset:32
  ds_read_b128 v[108:111], v27 offset:64
  ds_read_b128 v[112:115], v27 offset:96
  s_add_u32 s61, s52, 1
  s_and_b32 s61, s61, 7
  s_lshl_b32 s61, s61, 7
  v_add_u32 v27, s61, v26
  ds_read_b128 v[64:67], v27 offset:0
  ds_read_b128 v[68:71], v27 offset:32
  ds_read_b128 v[72:75], v27 offset:64
  ds_read_b128 v[76:79], v27 offset:96
  s_waitcnt lgkmcnt(6)
  v_dot2c_f32_bf16 v28, v124, v100
  v_dot2c_f32_bf16 v29, v125, v101
  v_dot2c_f32_bf16 v28, v126, v102
  v_dot2c_f32_bf16 v29, v127, v103
  v_dot2c_f32_bf16 v28, v128, v104
  v_dot2c_f32_bf16 v29, v129, v105
  v_dot2c_f32_bf16 v28, v130, v106
  v_dot2c_f32_bf16 v29, v131, v107
  s_add_u32 s61, s52, 2
  s_and_b32 s61, s61, 7
  s_lshl_b32 s61, s61, 7
  v_add_u32 v27, s61, v26
  ds_read_b128 v[100:103], v27 offset:0
  ds_read_b128 v[104:107], v27 offset:32
  s_waitcnt lgkmcnt(6)
  v_dot2c_f32_bf16 v28, v132, v108
  v_dot2c_f32_bf16 v29, v133, v109
  v_dot2c_f32_bf16 v28, v134, v110
  v_dot2c_f32_bf16 v29, v135, v111
  v_dot2c_f32_bf16 v28, v136, v112
  v_dot2c_f32_bf16 v29, v137, v113
  v_dot2c_f32_bf16 v28, v138, v114
  v_dot2c_f32_bf16 v29, v139, v115
  ds_read_b128 v[108:111], v27 offset:64
  ds_read_b128 v[112:115], v27 offset:96
  s_waitcnt lgkmcnt(6)
  v_dot2c_f32_bf16 v28, v140, v64
  v_dot2c_f32_bf16 v29, v141, v65
  v_dot2c_f32_bf16 v28, v142, v66
  v_dot2c_f32_bf16 v29, v143, v67
  v_dot2c_f32_bf16 v28, v144, v68
  v_dot2c_f32_bf16 v29, v145, v69
  v_dot2c_f32_bf16 v28, v146, v70
  v_dot2c_f32_bf16 v29, v147, v71
  s_add_u32 s61, s52, 3
  s_and_b32 s61, s61, 7
  s_lshl_b32 s61, s61, 7
  v_add_u32 v27, s61, v26
  ds_read_b128 v[64:67], v27 offset:0
  ds_read_b128 v[68:71], v27 offset:32
  s_waitcnt lgkmcnt(6)
  v_dot2c_f32_bf16 v28, v148, v72
  v_dot2c_f32_bf16 v29, v149, v73
  v_dot2c_f32_bf16 v28, v150, v74
  v_dot2c_f32_bf16 v29, v151, v75
  v_dot2c_f32_bf16 v28, v152, v76
  v_dot2c_f32_bf16 v29, v153, v77
  v_dot2c_f32_bf16 v28, v154, v78
  v_dot2c_f32_bf16 v29, v155, v79
  ds_read_b128 v[72:75], v27 offset:64
  ds_read_b128 v[76:79], v27 offset:96
  s_waitcnt lgkmcnt(6)
  v_dot2c_f32_bf16 v28, v156, v100
  v_dot2c_f32_bf16 v29, v157, v101
  v_dot2c_f32_bf16 v28, v158, v102
  v_dot2c_f32_bf16 v29, v159, v103
  v_dot2c_f32_bf16 v28, v160, v104
  v_dot2c_f32_bf16 v29, v161, v105
  v_dot2c_f32_bf16 v28, v162, v106
  v_dot2c_f32_bf16 v29, v163, v107
  s_add_u32 s61, s52, 4
  s_and_b32 s61, s61, 7
  s_lshl_b32 s61, s61, 7
  v_add_u32 v27, s61, v26
  ds_read_b128 v[100:103], v27 offset:0
  ds_read_b128 v[104:107], v27 offset:32
  s_waitcnt lgkmcnt(6)
  v_dot2c_f32_bf16 v28, v164, v108
  v_dot2c_f32_bf16 v29, v165, v109
  v_dot2c_f32_bf16 v28, v166, v110
  v_dot2c_f32_bf16 v29, v167, v111
  v_dot2c_f32_bf16 v28, v168, v112
  v_dot2c_f32_bf16 v29, v169, v113
  v_dot2c_f32_bf16 v28, v170, v114
  v_dot2c_f32_bf16 v29, v171, v115
  ds_read_b128 v[108:111], v27 offset:64
  ds_read_b128 v[112:115], v27 offset:96
  s_waitcnt lgkmcnt(6)
  v_dot2c_f32_bf16 v28, v172, v64
  v_dot2c_f32_bf16 v29, v173, v65
  v_dot2c_f32_bf16 v28, v174, v66
  v_dot2c_f32_bf16 v29, v175, v67
  v_dot2c_f32_bf16 v28, v176, v68
  v_dot2c_f32_bf16 v29, v177, v69
  v_dot2c_f32_bf16 v28, v178, v70
  v_dot2c_f32_bf16 v29, v179, v71
  s_add_u32 s61, s52, 5
  s_and_b32 s61, s61, 7
  s_lshl_b32 s61, s61, 7
  v_add_u32 v27, s61, v26
  ds_read_b128 v[64:67], v27 offset:0
  ds_read_b128 v[68:71], v27 offset:32
  s_waitcnt lgkmcnt(6)
  v_dot2c_f32_bf16 v28, v180, v72
  v_dot2c_f32_bf16 v29, v181, v73
  v_dot2c_f32_bf16 v28, v182, v74
  v_dot2c_f32_bf16 v29, v183, v75
  v_dot2c_f32_bf16 v28, v184, v76
  v_dot2c_f32_bf16 v29, v185, v77
  v_dot2c_f32_bf16 v28, v186, v78
  v_dot2c_f32_bf16 v29, v187, v79
  ds_read_b128 v[72:75], v27 offset:64
  ds_read_b128 v[76:79], v27 offset:96
  s_waitcnt lgkmcnt(6)
  v_dot2c_f32_bf16 v28, v188, v100
  v_dot2c_f32_bf16 v29, v189, v101
  v_dot2c_f32_bf16 v28, v190, v102
  v_dot2c_f32_bf16 v29, v191, v103
  v_dot2c_f32_bf16 v28, v192, v104
  v_dot2c_f32_bf16 v29, v193, v105
  v_dot2c_f32_bf16 v28, v194, v106
  v_dot2c_f32_bf16 v29, v195, v107
  s_add_u32 s61, s52, 6
  s_and_b32 s61, s61, 7
  s_lshl_b32 s61, s61, 7
  v_add_u32 v27, s61, v26
  ds_read_b128 v[100:103], v27 offset:0
  ds_read_b128 v[104:107], v27 offset:32
  s_waitcnt lgkmcnt(6)
  v_dot2c_f32_bf16 v28, v196, v108
  v_dot2c_f32_bf16 v29, v197, v109
  v_dot2c_f32_bf16 v28, v198, v110
  v_dot2c_f32_bf16 v29, v199, v111
  v_dot2c_f32_bf16 v28, v200, v112
  v_dot2c_f32_bf16 v29, v201, v113
  v_dot2c_f32_bf16 v28, v202, v114
  v_dot2c_f32_bf16 v29, v203, v115
  ds_read_b128 v[108:111], v27 offset:64
  ds_read_b128 v[112:115], v27 offset:96
  s_waitcnt lgkmcnt(6)
  v_dot2c_f32_bf16 v28, v204, v64
  v_dot2c_f32_bf16 v29, v205, v65
  v_dot2c_f32_bf16 v28, v206, v66
  v_dot2c_f32_bf16 v29, v207, v67
  v_dot2c_f32_bf16 v28, v208, v68
  v_dot2c_f32_bf16 v29, v209, v69
  v_dot2c_f32_bf16 v28, v210, v70
  v_dot2c_f32_bf16 v29, v211, v71
  s_add_u32 s61, s52, 7
  s_and_b32 s61, s61, 7
  s_lshl_b32 s61, s61, 7
  v_add_u32 v27, s61, v26
  ds_read_b128 v[64:67], v27 offset:0
  ds_read_b128 v[68:71], v27 offset:32
  s_waitcnt lgkmcnt(6)
  v_dot2c_f32_bf16 v28, v212, v72
  v_dot2c_f32_bf16 v29, v213, v73
  v_dot2c_f32_bf16 v28, v214, v74
  v_dot2c_f32_bf16 v29, v215, v75
  v_dot2c_f32_bf16 v28, v216, v76
  v_dot2c_f32_bf16 v29, v217, v77
  v_dot2c_f32_bf16 v28, v218, v78
  v_dot2c_f32_bf16 v29, v219, v79
  ds_read_b128 v[72:75], v27 offset:64
  ds_read_b128 v[76:79], v27 offset:96
  s_waitcnt lgkmcnt(6)
  v_dot2c_f32_bf16 v28, v220, v100
  v_dot2c_f32_bf16 v29, v221, v101
  v_dot2c_f32_bf16 v28, v222, v102
  v_dot2c_f32_bf16 v29, v223, v103
  v_dot2c_f32_bf16 v28, v224, v104
  v_dot2c_f32_bf16 v29, v225, v105
  v_dot2c_f32_bf16 v28, v226, v106
  v_dot2c_f32_bf16 v29, v227, v107
  s_waitcnt lgkmcnt(4)
  v_dot2c_f32_bf16 v28, v228, v108
  v_dot2c_f32_bf16 v29, v229, v109
  v_dot2c_f32_bf16 v28, v230, v110
  v_dot2c_f32_bf16 v29, v231, v111
  v_dot2c_f32_bf16 v28, v232, v112
  v_dot2c_f32_bf16 v29, v233, v113
  v_dot2c_f32_bf16 v28, v234, v114
  v_dot2c_f32_bf16 v29, v235, v115
  s_waitcnt lgkmcnt(2)
  v_dot2c_f32_bf16 v28, v236, v64
  v_dot2c_f32_bf16 v29, v237, v65
  v_dot2c_f32_bf16 v28, v238, v66
  v_dot2c_f32_bf16 v29, v239, v67
  v_dot2c_f32_bf16 v28, v240, v68
  v_dot2c_f32_bf16 v29, v241, v69
  v_dot2c_f32_bf16 v28, v242, v70
  v_dot2c_f32_bf16 v29, v243, v71
  s_waitcnt lgkmcnt(0)
  v_dot2c_f32_bf16 v28, v244, v72
  v_dot2c_f32_bf16 v29, v245, v73
  v_dot2c_f32_bf16 v28, v246, v74
  v_dot2c_f32_bf16 v29, v247, v75
  v_dot2c_f32_bf16 v28, v248, v76
  v_dot2c_f32_bf16 v29, v249, v77
  v_dot2c_f32_bf16 v28, v250, v78
  v_dot2c_f32_bf16 v29, v251, v79
  s_nop 3
  v_add_f32 v28, v28, v29
  v_and_b32 v41, 31, v2
  v_mov_b32 v29, v28
  v_lshlrev_b32 v41, 2, v41
  s_nop 0
  v_permlane32_swap_b32 v28, v29
  s_nop 0
  v_add_f32 v40, v28, v29
  v_mul_f32 v40, 0xbfb8aa3b, v40
  v_exp_f32 v40, v40
  s_nop 0
  v_add_f32 v40, 1.0, v40
  v_rcp_f32 v40, v40
  s_nop 0
  buffer_store_dword v40, v41, s[32:35], s7 offen sc1
F_nogate:
  s_nop 11
  v_pk_mul_f32 v[100:101], v[80:81], s[76:77] op_sel_hi:[1,0]
  v_pk_mul_f32 v[102:103], v[82:83], s[76:77] op_sel_hi:[1,0]
  v_pk_mul_f32 v[104:105], v[84:85], s[76:77] op_sel_hi:[1,0]
  v_pk_mul_f32 v[106:107], v[86:87], s[76:77] op_sel_hi:[1,0]
  s_nop 11
  v_pk_mul_f32 v[108:109], v[88:89], s[76:77] op_sel_hi:[1,0]
  v_pk_mul_f32 v[110:111], v[90:91], s[76:77] op_sel_hi:[1,0]
  v_pk_mul_f32 v[112:113], v[92:93], s[76:77] op_sel_hi:[1,0]
  v_pk_mul_f32 v[114:115], v[94:95], s[76:77] op_sel_hi:[1,0]
  v_exp_f32 v100, v100
  v_exp_f32 v101, v101
  v_exp_f32 v102, v102
  v_exp_f32 v108, v108
  v_exp_f32 v109, v109
  v_exp_f32 v110, v110
  v_exp_f32 v103, v103
  v_exp_f32 v104, v104
  v_exp_f32 v105, v105
  v_exp_f32 v111, v111
  v_exp_f32 v112, v112
  v_exp_f32 v113, v113
  v_exp_f32 v106, v106
  v_exp_f32 v107, v107
  v_exp_f32 v114, v114
  v_exp_f32 v115, v115
  v_pk_add_f32 v[100:101], v[100:101], 1.0 op_sel_hi:[1,0]
  v_pk_add_f32 v[102:103], v[102:103], 1.0 op_sel_hi:[1,0]
  v_pk_add_f32 v[104:105], v[104:105], 1.0 op_sel_hi:[1,0]
  v_pk_add_f32 v[106:107], v[106:107], 1.0 op_sel_hi:[1,0]
  v_pk_add_f32 v[108:109], v[108:109], 1.0 op_sel_hi:[1,0]
  v_pk_add_f32 v[110:111], v[110:111], 1.0 op_sel_hi:[1,0]
  v_pk_add_f32 v[112:113], v[112:113], 1.0 op_sel_hi:[1,0]
  v_pk_add_f32 v[114:115], v[114:115], 1.0 op_sel_hi:[1,0]
  v_rcp_f32 v100, v100
  v_rcp_f32 v101, v101
  v_rcp_f32 v102, v102
  v_rcp_f32 v108, v108
  v_rcp_f32 v109, v109
  v_rcp_f32 v110, v110
  v_rcp_f32 v103, v103
  v_rcp_f32 v104, v104
  v_rcp_f32 v105, v105
  v_rcp_f32 v111, v111
  v_rcp_f32 v112, v112
  v_rcp_f32 v113, v113
  v_rcp_f32 v106, v106
  v_rcp_f32 v107, v107
  v_rcp_f32 v114, v114
  v_rcp_f32 v115, v115
  s_nop 0
  v_pk_mul_f32 v[100:101], v[80:81], v[100:101]
  v_pk_mul_f32 v[102:103], v[82:83], v[102:103]
  v_pk_mul_f32 v[104:105], v[84:85], v[104:105]
  v_pk_mul_f32 v[106:107], v[86:87], v[106:107]
  s_nop 0
  v_pk_mul_f32 v[108:109], v[88:89], v[108:109]
  v_pk_mul_f32 v[110:111], v[90:91], v[110:111]
  v_pk_mul_f32 v[112:113], v[92:93], v[112:113]
  v_pk_mul_f32 v[114:115], v[94:95], v[114:115]
  v_cvt_pk_bf16_f32 v140, v100, v101
  v_cvt_pk_bf16_f32 v141, v102, v103
  v_cvt_pk_bf16_f32 v142, v104, v105
  v_cvt_pk_bf16_f32 v143, v106, v107
  v_cvt_pk_bf16_f32 v144, v108, v109
  v_cvt_pk_bf16_f32 v145, v110, v111
  v_cvt_pk_bf16_f32 v146, v112, v113
  v_cvt_pk_bf16_f32 v147, v114, v115
  buffer_store_dwordx4 v[140:143], v3, s[32:35], s84 offen offset:0 sc1
  buffer_store_dwordx4 v[144:147], v3, s[32:35], s84 offen offset:1024 sc1
  s_mov_b32 s84, 0x04000000
  s_setprio 0
  s_waitcnt lgkmcnt(0)
F_attn:
  s_barrier
F_attn2:
  ds_write_b128 v8, v[116:119]
  ds_read_b128 v[8:11], v123
  ds_read_b128 v[12:15], v5
  ds_read_b64_tr_b16 v[16:17], v96 offset:0
  ds_read_b64_tr_b16 v[18:19], v97 offset:0
  ds_read_b64_tr_b16 v[20:21], v98 offset:0
  ds_read_b64_tr_b16 v[22:23], v99 offset:0
  s_waitcnt lgkmcnt(4)
  v_mfma_f32_32x32x16_bf16 v[48:63], v[12:15], v[8:11], 0
  s_nop 12
  v_max3_f32 v108, v48, v49, v50
  v_max_f32 v108, v108, v51
  v_max3_f32 v108, v108, v52, v53
  v_max3_f32 v108, v108, v54, v55
  v_max3_f32 v108, v108, v56, v57
  v_max3_f32 v108, v108, v58, v59
  v_max3_f32 v108, v108, v60, v61
  v_max3_f32 v108, v108, v62, v63
  v_mov_b32 v109, v108
  s_nop 1
  v_permlane32_swap_b32 v108, v109
  s_nop 0
  v_max_f32 v108, v108, v109
  v_sub_f32 v64, 0, v108
  v_sub_f32 v65, 0, v108
  v_sub_f32 v66, 0, v108
  v_sub_f32 v67, 0, v108
  v_sub_f32 v68, 0, v108
  v_sub_f32 v69, 0, v108
  v_sub_f32 v70, 0, v108
  v_sub_f32 v71, 0, v108
  v_sub_f32 v72, 0, v108
  v_sub_f32 v73, 0, v108
  v_sub_f32 v74, 0, v108
  v_sub_f32 v75, 0, v108
  v_sub_f32 v76, 0, v108
  v_sub_f32 v77, 0, v108
  v_sub_f32 v78, 0, v108
  v_sub_f32 v79, 0, v108
  s_nop 1
  v_mfma_f32_32x32x16_bf16 v[32:47], v[12:15], v[8:11], v[64:79]
  ds_read_b128 v[12:15], v5 offset:2064
  v_mov_b32 v28, 0xdddddddd
  s_mov_b32 s64, 0xffff
  s_mov_b32 s65, 0xffff
  v_mov_b32 v80, 0
  v_mov_b32 v81, 0
  v_mov_b32 v82, 0
  v_mov_b32 v83, 0
  v_mov_b32 v84, 0
  v_mov_b32 v85, 0
  v_mov_b32 v86, 0
  v_mov_b32 v87, 0
  v_mov_b32 v88, 0
  v_mov_b32 v89, 0
  v_mov_b32 v90, 0
  v_mov_b32 v91, 0
  v_mov_b32 v92, 0
  v_mov_b32 v93, 0
  v_mov_b32 v94, 0
  v_mov_b32 v95, 0
  s_cmp_eq_u64 s[96:97], 0
  s_cbranch_scc1 F_pr1
  s_setprio 1
F_pr1:
  v_exp_f32 v32, v32
  v_exp_f32 v33, v33
  v_exp_f32 v34, v34
  v_exp_f32 v35, v35
  v_exp_f32 v36, v36
  v_exp_f32 v37, v37
  s_waitcnt lgkmcnt(0)
  v_mfma_f32_32x32x16_bf16 v[48:63], v[12:15], v[8:11], v[64:79]
  ds_read_b128 v[12:15], v5 offset:4128
  s_add_u32 m0, s9, 24768
  s_add_u32 s62, s8, 12288
  buffer_load_dwordx4 v3, s[32:35], s62 offen lds
  v_exp_f32 v38, v38
  v_exp_f32 v39, v39
  s_add_u32 m0, s9, 33024
  s_add_u32 s62, s8, 16384
  buffer_load_dwordx4 v3, s[32:35], s62 offen lds
  v_exp_f32 v40, v40
  v_exp_f32 v41, v41
  s_waitcnt lgkmcnt(3)
  v_smfmac_f32_32x32x32_bf16 v[80:95], v[16:19], v[32:39], v28
  ds_read_b64_tr_b16 v[16:17], v96 offset:2064
  ds_read_b64_tr_b16 v[18:19], v97 offset:2064
  v_exp_f32 v42, v42
  v_exp_f32 v43, v43
  v_exp_f32 v44, v44
  v_exp_f32 v45, v45
  v_exp_f32 v46, v46
  v_exp_f32 v47, v47
  v_exp_f32 v48, v48
  v_exp_f32 v49, v49
  s_waitcnt lgkmcnt(3)
  v_smfmac_f32_32x32x32_bf16 v[80:95], v[20:23], v[40:47], v28
  ds_read_b64_tr_b16 v[20:21], v98 offset:2064
  ds_read_b64_tr_b16 v[22:23], v99 offset:2064
  v_exp_f32 v50, v50
  v_exp_f32 v51, v51
  v_exp_f32 v52, v52
  v_exp_f32 v53, v53
  s_waitcnt lgkmcnt(4)
  v_mfma_f32_32x32x16_bf16 v[32:47], v[12:15], v[8:11], v[64:79]
  ds_read_b128 v[12:15], v5 offset:6192
  buffer_store_dwordx4 v[140:143], v3, s[32:35], s84 offen offset:0 sc1
  v_exp_f32 v54, v54
  v_exp_f32 v55, v55
  v_exp_f32 v56, v56
  v_exp_f32 v57, v57
  s_waitcnt lgkmcnt(3)
  v_smfmac_f32_32x32x32_bf16 v[80:95], v[16:19], v[48:55], v28
  ds_read_b64_tr_b16 v[16:17], v96 offset:4128
  ds_read_b64_tr_b16 v[18:19], v97 offset:4128
  v_exp_f32 v58, v58
  v_exp_f32 v59, v59
  v_exp_f32 v60, v60
  v_exp_f32 v61, v61
  s_add_u32 m0, s78, 0
  s_nop 0
  buffer_load_dwordx4 v120, s[36:39], s40 offen lds
  s_add_u32 m0, s78, 1024
  s_nop 0
  buffer_load_dwordx4 v120, s[36:39], s41 offen lds
  v_exp_f32 v62, v62
  v_exp_f32 v63, v63
  v_exp_f32 v32, v32
  v_exp_f32 v33, v33
  s_waitcnt lgkmcnt(3)
  v_smfmac_f32_32x32x32_bf16 v[80:95], v[20:23], v[56:63], v28
  ds_read_b64_tr_b16 v[20:21], v98 offset:4128
  ds_read_b64_tr_b16 v[22:23], v99 offset:4128
  v_exp_f32 v34, v34
  v_exp_f32 v35, v35
  v_exp_f32 v36, v36
  v_exp_f32 v37, v37
  s_waitcnt lgkmcnt(4)
  v_mfma_f32_32x32x16_bf16 v[48:63], v[12:15], v[8:11], v[64:79]
  ds_read_b128 v[12:15], v5 offset:8256
  buffer_store_dwordx4 v[144:147], v3, s[32:35], s84 offen offset:1024 sc1
  v_exp_f32 v38, v38
  v_exp_f32 v39, v39
  v_exp_f32 v40, v40
  v_exp_f32 v41, v41
  s_waitcnt lgkmcnt(3)
  v_smfmac_f32_32x32x32_bf16 v[80:95], v[16:19], v[32:39], v28
  ds_read_b64_tr_b16 v[16:17], v96 offset:6192
  ds_read_b64_tr_b16 v[18:19], v97 offset:6192
  v_exp_f32 v42, v42
  v_exp_f32 v43, v43
  v_exp_f32 v44, v44
  v_exp_f32 v45, v45
  v_exp_f32 v46, v46
  v_exp_f32 v47, v47
  v_exp_f32 v48, v48
  v_exp_f32 v49, v49
  s_waitcnt lgkmcnt(3)
  v_smfmac_f32_32x32x32_bf16 v[80:95], v[20:23], v[40:47], v28
  ds_read_b64_tr_b16 v[20:21], v98 offset:6192
  ds_read_b64_tr_b16 v[22:23], v99 offset:6192
  v_exp_f32 v50, v50
  v_exp_f32 v51, v51
  v_exp_f32 v52, v52
  v_exp_f32 v53, v53
  s_waitcnt lgkmcnt(4)
  v_mfma_f32_32x32x16_bf16 v[32:47], v[12:15], v[8:11], v[64:79]
  ds_read_b128 v[12:15], v5 offset:10320
  buffer_store_dwordx4 v[148:151], v3, s[32:35], s101 offen offset:2048 sc1
  v_exp_f32 v54, v54
  v_exp_f32 v55, v55
  v_exp_f32 v56, v56
  v_exp_f32 v57, v57
  s_waitcnt lgkmcnt(3)
  v_smfmac_f32_32x32x32_bf16 v[80:95], v[16:19], v[48:55], v28
  ds_read_b64_tr_b16 v[16:17], v96 offset:8256
  ds_read_b64_tr_b16 v[18:19], v97 offset:8256
  v_exp_f32 v58, v58
  v_exp_f32 v59, v59
  v_exp_f32 v60, v60
  v_exp_f32 v61, v61
  v_exp_f32 v62, v62
  v_exp_f32 v63, v63
  v_exp_f32 v32, v32
  v_exp_f32 v33, v33
  s_waitcnt lgkmcnt(3)
  v_smfmac_f32_32x32x32_bf16 v[80:95], v[20:23], v[56:63], v28
  ds_read_b64_tr_b16 v[20:21], v98 offset:8256
  ds_read_b64_tr_b16 v[22:23], v99 offset:8256
  v_exp_f32 v34, v34
  v_exp_f32 v35, v35
  v_exp_f32 v36, v36
  v_exp_f32 v37, v37
  s_waitcnt lgkmcnt(4)
  v_mfma_f32_32x32x16_bf16 v[48:63], v[12:15], v[8:11], v[64:79]
  ds_read_b128 v[12:15], v5 offset:12384
  buffer_store_dwordx4 v[152:155], v3, s[32:35], s101 offen offset:3072 sc1
  v_exp_f32 v38, v38
  v_exp_f32 v39, v39
  v_exp_f32 v40, v40
  v_exp_f32 v41, v41
  s_waitcnt lgkmcnt(3)
  v_smfmac_f32_32x32x32_bf16 v[80:95], v[16:19], v[32:39], v28
  ds_read_b64_tr_b16 v[16:17], v96 offset:10320
  ds_read_b64_tr_b16 v[18:19], v97 offset:10320
  v_exp_f32 v42, v42
  v_exp_f32 v43, v43
  v_exp_f32 v44, v44
  v_exp_f32 v45, v45
  v_exp_f32 v46, v46
  v_exp_f32 v47, v47
  v_exp_f32 v48, v48
  v_exp_f32 v49, v49
  s_waitcnt lgkmcnt(3)
  v_smfmac_f32_32x32x32_bf16 v[80:95], v[20:23], v[40:47], v28
  ds_read_b64_tr_b16 v[20:21], v98 offset:10320
  ds_read_b64_tr_b16 v[22:23], v99 offset:10320
  v_exp_f32 v50, v50
  v_exp_f32 v51, v51
  v_exp_f32 v52, v52
  v_exp_f32 v53, v53
  s_waitcnt lgkmcnt(4)
  v_mfma_f32_32x32x16_bf16 v[32:47], v[12:15], v[8:11], v[64:79]
  ds_read_b128 v[12:15], v5 offset:14448
  v_exp_f32 v54, v54
  v_exp_f32 v55, v55
  v_exp_f32 v56, v56
  v_exp_f32 v57, v57
  s_waitcnt lgkmcnt(3)
  v_smfmac_f32_32x32x32_bf16 v[80:95], v[16:19], v[48:55], v28
  ds_read_b64_tr_b16 v[16:17], v96 offset:12384
  ds_read_b64_tr_b16 v[18:19], v97 offset:12384
  v_exp_f32 v58, v58
  v_exp_f32 v59, v59
  v_exp_f32 v60, v60
  v_exp_f32 v61, v61
  v_exp_f32 v62, v62
  v_exp_f32 v63, v63
  s_cmp_eq_u64 s[96:97], 0
  s_cbranch_scc1 F_pr2
  s_setprio 0
F_pr2:
  v_exp_f32 v32, v32
  v_exp_f32 v33, v33
  s_waitcnt lgkmcnt(3)
  v_smfmac_f32_32x32x32_bf16 v[80:95], v[20:23], v[56:63], v28
  ds_read_b64_tr_b16 v[20:21], v98 offset:12384
  ds_read_b64_tr_b16 v[22:23], v99 offset:12384
  v_exp_f32 v34, v34
  v_exp_f32 v35, v35
  v_exp_f32 v36, v36
  v_exp_f32 v37, v37
  s_waitcnt lgkmcnt(4)
  v_mfma_f32_32x32x16_bf16 v[48:63], v[12:15], v[8:11], v[64:79]
  ds_read_b128 v[12:15], v5 offset:16512
  v_exp_f32 v38, v38
  v_exp_f32 v39, v39
  v_exp_f32 v40, v40
  v_exp_f32 v41, v41
  s_waitcnt lgkmcnt(3)
  v_smfmac_f32_32x32x32_bf16 v[80:95], v[16:19], v[32:39], v28
  ds_read_b64_tr_b16 v[16:17], v96 offset:14448
  ds_read_b64_tr_b16 v[18:19], v97 offset:14448
  v_exp_f32 v42, v42
  v_exp_f32 v43, v43
  v_exp_f32 v44, v44
  v_exp_f32 v45, v45
  v_exp_f32 v46, v46
  v_exp_f32 v47, v47
  v_exp_f32 v48, v48
  v_exp_f32 v49, v49
  s_waitcnt lgkmcnt(3)
  v_smfmac_f32_32x32x32_bf16 v[80:95], v[20:23], v[40:47], v28
  ds_read_b64_tr_b16 v[20:21], v98 offset:14448
  ds_read_b64_tr_b16 v[22:23], v99 offset:14448
  v_exp_f32 v50, v50
  v_exp_f32 v51, v51
  v_exp_f32 v52, v52
  v_exp_f32 v53, v53
  s_waitcnt lgkmcnt(4)
  v_mfma_f32_32x32x16_bf16 v[32:47], v[12:15], v[8:11], v[64:79]
  ds_read_b128 v[12:15], v5 offset:18576
  v_exp_f32 v54, v54
  v_exp_f32 v55, v55
  s_add_u32 m0, s9, 41280
  s_add_u32 s62, s8, 20480
  buffer_load_dwordx4 v3, s[32:35], s62 offen lds
  v_exp_f32 v56, v56
  v_exp_f32 v57, v57
  s_waitcnt lgkmcnt(3)
  v_smfmac_f32_32x32x32_bf16 v[80:95], v[16:19], v[48:55], v28
  ds_read_b64_tr_b16 v[16:17], v96 offset:16512
  ds_read_b64_tr_b16 v[18:19], v97 offset:16512
  v_exp_f32 v58, v58
  v_exp_f32 v59, v59
  v_exp_f32 v60, v60
  v_exp_f32 v61, v61
  v_exp_f32 v62, v62
  v_exp_f32 v63, v63
  s_waitcnt vmcnt(7)
  s_barrier
  s_cmp_eq_u64 s[96:97], 0
  s_cbranch_scc1 F_pr3
  s_setprio 1
F_pr3:
  v_exp_f32 v32, v32
  v_exp_f32 v33, v33
  s_waitcnt lgkmcnt(3)
  v_smfmac_f32_32x32x32_bf16 v[80:95], v[20:23], v[56:63], v28
  ds_read_b64_tr_b16 v[20:21], v98 offset:16512
  ds_read_b64_tr_b16 v[22:23], v99 offset:16512
  v_exp_f32 v34, v34
  v_exp_f32 v35, v35
  v_exp_f32 v36, v36
  v_exp_f32 v37, v37
  s_waitcnt lgkmcnt(4)
  v_mfma_f32_32x32x16_bf16 v[48:63], v[12:15], v[8:11], v[64:79]
  ds_read_b128 v[12:15], v5 offset:20640
  v_exp_f32 v38, v38
  v_exp_f32 v39, v39
  s_add_u32 m0, s9, 49536
  s_add_u32 s62, s8, 24576
  buffer_load_dwordx4 v3, s[32:35], s62 offen lds
  v_exp_f32 v40, v40
  v_exp_f32 v41, v41
  s_waitcnt lgkmcnt(3)
  v_smfmac_f32_32x32x32_bf16 v[80:95], v[16:19], v[32:39], v28
  ds_read_b64_tr_b16 v[16:17], v96 offset:18576
  ds_read_b64_tr_b16 v[18:19], v97 offset:18576
  v_exp_f32 v42, v42
  v_exp_f32 v43, v43
  v_exp_f32 v44, v44
  v_exp_f32 v45, v45
  v_exp_f32 v46, v46
  v_exp_f32 v47, v47
  v_exp_f32 v48, v48
  v_exp_f32 v49, v49
  s_waitcnt lgkmcnt(3)
  v_smfmac_f32_32x32x32_bf16 v[80:95], v[20:23], v[40:47], v28
  ds_read_b64_tr_b16 v[20:21], v98 offset:18576
  ds_read_b64_tr_b16 v[22:23], v99 offset:18576
  v_exp_f32 v50, v50
  v_exp_f32 v51, v51
  v_exp_f32 v52, v52
  v_exp_f32 v53, v53
  s_waitcnt lgkmcnt(4)
  v_mfma_f32_32x32x16_bf16 v[32:47], v[12:15], v[8:11], v[64:79]
  ds_read_b128 v[12:15], v5 offset:22704
  s_waitcnt vmcnt(5)
  ds_read_b64_tr_b16 v[124:125], v121 offset:0
  ds_read_b64_tr_b16 v[126:127], v122 offset:0
  ds_read_b64_tr_b16 v[128:129], v121 offset:64
  ds_read_b64_tr_b16 v[130:131], v122 offset:64
  v_exp_f32 v54, v54
  v_exp_f32 v55, v55
  s_add_u32 m0, s9, 57792
  s_add_u32 s62, s8, 28672
  buffer_load_dwordx4 v3, s[32:35], s62 offen lds
  v_exp_f32 v56, v56
  v_exp_f32 v57, v57
  s_waitcnt lgkmcnt(3)
  v_smfmac_f32_32x32x32_bf16 v[80:95], v[16:19], v[48:55], v28
  ds_read_b64_tr_b16 v[16:17], v96 offset:20640
  ds_read_b64_tr_b16 v[18:19], v97 offset:20640
  v_exp_f32 v58, v58
  v_exp_f32 v59, v59
  v_exp_f32 v60, v60
  v_exp_f32 v61, v61
  s_waitcnt lgkmcnt(4)
  buffer_store_dwordx4 v[124:127], v3, s[32:35], s42 offen sc1
  v_exp_f32 v62, v62
  v_exp_f32 v63, v63
  v_exp_f32 v32, v32
  v_exp_f32 v33, v33
  s_waitcnt lgkmcnt(3)
  v_smfmac_f32_32x32x32_bf16 v[80:95], v[20:23], v[56:63], v28
  ds_read_b64_tr_b16 v[20:21], v98 offset:20640
  ds_read_b64_tr_b16 v[22:23], v99 offset:20640
  v_exp_f32 v34, v34
  v_exp_f32 v35, v35
  v_exp_f32 v36, v36
  v_exp_f32 v37, v37
  s_waitcnt lgkmcnt(4)
  v_mfma_f32_32x32x16_bf16 v[48:63], v[12:15], v[8:11], v[64:79]
  ds_read_b128 v[12:15], v5 offset:24768
  buffer_store_dwordx4 v[128:131], v3, s[32:35], s43 offen sc1
  v_exp_f32 v38, v38
  v_exp_f32 v39, v39
  s_add_u32 m0, s9, 66048
  s_add_u32 s62, s8, 32768
  buffer_load_dwordx4 v3, s[32:35], s62 offen lds
  v_exp_f32 v40, v40
  v_exp_f32 v41, v41
  s_waitcnt lgkmcnt(3)
  v_smfmac_f32_32x32x32_bf16 v[80:95], v[16:19], v[32:39], v28
  ds_read_b64_tr_b16 v[16:17], v96 offset:22704
  ds_read_b64_tr_b16 v[18:19], v97 offset:22704
  v_exp_f32 v42, v42
  v_exp_f32 v43, v43
  v_exp_f32 v44, v44
  v_exp_f32 v45, v45
  v_exp_f32 v46, v46
  v_exp_f32 v47, v47
  v_exp_f32 v48, v48
  v_exp_f32 v49, v49
  s_waitcnt lgkmcnt(3)
  v_smfmac_f32_32x32x32_bf16 v[80:95], v[20:23], v[40:47], v28
  ds_read_b64_tr_b16 v[20:21], v98 offset:22704
  ds_read_b64_tr_b16 v[22:23], v99 offset:22704
  v_exp_f32 v50, v50
  v_exp_f32 v51, v51
  v_exp_f32 v52, v52
  v_exp_f32 v53, v53
  s_waitcnt lgkmcnt(4)
  v_mfma_f32_32x32x16_bf16 v[32:47], v[12:15], v[8:11], v[64:79]
  ds_read_b128 v[12:15], v5 offset:26832
  v_exp_f32 v54, v54
  v_exp_f32 v55, v55
  s_add_u32 m0, s9, 74304
  s_add_u32 s62, s8, 36864
  buffer_load_dwordx4 v3, s[32:35], s62 offen lds
  v_exp_f32 v56, v56
  v_exp_f32 v57, v57
  s_waitcnt lgkmcnt(3)
  v_smfmac_f32_32x32x32_bf16 v[80:95], v[16:19], v[48:55], v28
  ds_read_b64_tr_b16 v[16:17], v96 offset:24768
  ds_read_b64_tr_b16 v[18:19], v97 offset:24768
  v_exp_f32 v58, v58
  v_exp_f32 v59, v59
  v_exp_f32 v60, v60
  v_exp_f32 v61, v61
  v_exp_f32 v62, v62
  v_exp_f32 v63, v63
  v_exp_f32 v32, v32
  v_exp_f32 v33, v33
  s_waitcnt lgkmcnt(3)
  v_smfmac_f32_32x32x32_bf16 v[80:95], v[20:23], v[56:63], v28
  ds_read_b64_tr_b16 v[20:21], v98 offset:24768
  ds_read_b64_tr_b16 v[22:23], v99 offset:24768
  v_exp_f32 v34, v34
  v_exp_f32 v35, v35
  v_exp_f32 v36, v36
  v_exp_f32 v37, v37
  s_waitcnt lgkmcnt(4)
  v_mfma_f32_32x32x16_bf16 v[48:63], v[12:15], v[8:11], v[64:79]
  ds_read_b128 v[12:15], v5 offset:28896
  v_exp_f32 v38, v38
  v_exp_f32 v39, v39
  s_add_u32 m0, s9, 82560
  s_add_u32 s62, s8, 40960
  buffer_load_dwordx4 v3, s[32:35], s62 offen lds
  v_exp_f32 v40, v40
  v_exp_f32 v41, v41
  s_waitcnt lgkmcnt(3)
  v_smfmac_f32_32x32x32_bf16 v[80:95], v[16:19], v[32:39], v28
  ds_read_b64_tr_b16 v[16:17], v96 offset:26832
  ds_read_b64_tr_b16 v[18:19], v97 offset:26832
  v_exp_f32 v42, v42
  v_exp_f32 v43, v43
  v_exp_f32 v44, v44
  v_exp_f32 v45, v45
  v_exp_f32 v46, v46
  v_exp_f32 v47, v47
  s_cmp_eq_u64 s[96:97], 0
  s_cbranch_scc1 F_pr4
  s_setprio 0
F_pr4:
  v_exp_f32 v48, v48
  v_exp_f32 v49, v49
  s_waitcnt lgkmcnt(3)
  v_smfmac_f32_32x32x32_bf16 v[80:95], v[20:23], v[40:47], v28
  ds_read_b64_tr_b16 v[20:21], v98 offset:26832
  ds_read_b64_tr_b16 v[22:23], v99 offset:26832
  v_exp_f32 v50, v50
  v_exp_f32 v51, v51
  v_exp_f32 v52, v52
  v_exp_f32 v53, v53
  s_waitcnt lgkmcnt(4)
  v_mfma_f32_32x32x16_bf16 v[32:47], v[12:15], v[8:11], v[64:79]
  ds_read_b128 v[12:15], v5 offset:30960
  v_exp_f32 v54, v54
  v_exp_f32 v55, v55
  s_add_u32 m0, s9, 90816
  s_add_u32 s62, s8, 45056
  buffer_load_dwordx4 v3, s[32:35], s62 offen lds
  v_exp_f32 v56, v56
  v_exp_f32 v57, v57
  s_waitcnt lgkmcnt(3)
  v_smfmac_f32_32x32x32_bf16 v[80:95], v[16:19], v[48:55], v28
  ds_read_b64_tr_b16 v[16:17], v96 offset:28896
  ds_read_b64_tr_b16 v[18:19], v97 offset:28896
  v_exp_f32 v58, v58
  v_exp_f32 v59, v59
  v_exp_f32 v60, v60
  v_exp_f32 v61, v61
  v_exp_f32 v62, v62
  v_exp_f32 v63, v63
  v_exp_f32 v32, v32
  v_exp_f32 v33, v33
  s_waitcnt lgkmcnt(3)
  v_smfmac_f32_32x32x32_bf16 v[80:95], v[20:23], v[56:63], v28
  ds_read_b64_tr_b16 v[20:21], v98 offset:28896
  ds_read_b64_tr_b16 v[22:23], v99 offset:28896
  v_exp_f32 v34, v34
  v_exp_f32 v35, v35
  v_exp_f32 v36, v36
  v_exp_f32 v37, v37
  s_waitcnt lgkmcnt(4)
  v_mfma_f32_32x32x16_bf16 v[48:63], v[12:15], v[8:11], v[64:79]
  ds_read_b128 v[12:15], v5 offset:33024
  v_exp_f32 v38, v38
  v_exp_f32 v39, v39
  s_add_u32 m0, s9, 99072
  s_add_u32 s62, s8, 49152
  buffer_load_dwordx4 v3, s[32:35], s62 offen lds
  v_exp_f32 v40, v40
  v_exp_f32 v41, v41
  s_waitcnt lgkmcnt(3)
  v_smfmac_f32_32x32x32_bf16 v[80:95], v[16:19], v[32:39], v28
  ds_read_b64_tr_b16 v[16:17], v96 offset:30960
  ds_read_b64_tr_b16 v[18:19], v97 offset:30960
  v_exp_f32 v42, v42
  v_exp_f32 v43, v43
  v_exp_f32 v44, v44
  v_exp_f32 v45, v45
  v_exp_f32 v46, v46
  v_exp_f32 v47, v47
  v_exp_f32 v48, v48
  v_exp_f32 v49, v49
  s_waitcnt lgkmcnt(3)
  v_smfmac_f32_32x32x32_bf16 v[80:95], v[20:23], v[40:47], v28
  ds_read_b64_tr_b16 v[20:21], v98 offset:30960
  ds_read_b64_tr_b16 v[22:23], v99 offset:30960
  v_exp_f32 v50, v50
  v_exp_f32 v51, v51
  v_exp_f32 v52, v52
  v_exp_f32 v53, v53
  s_waitcnt lgkmcnt(4)
  v_mfma_f32_32x32x16_bf16 v[32:47], v[12:15], v[8:11], v[64:79]
  ds_read_b128 v[12:15], v5 offset:35088
  v_exp_f32 v54, v54
  v_exp_f32 v55, v55
  s_add_u32 m0, s9, 107328
  s_add_u32 s62, s8, 53248
  buffer_load_dwordx4 v3, s[32:35], s62 offen lds
  v_exp_f32 v56, v56
  v_exp_f32 v57, v57
  s_waitcnt lgkmcnt(3)
  v_smfmac_f32_32x32x32_bf16 v[80:95], v[16:19], v[48:55], v28
  ds_read_b64_tr_b16 v[16:17], v96 offset:33024
  ds_read_b64_tr_b16 v[18:19], v97 offset:33024
  v_exp_f32 v58, v58
  v_exp_f32 v59, v59
  v_exp_f32 v60, v60
  v_exp_f32 v61, v61
  v_exp_f32 v62, v62
  v_exp_f32 v63, v63
  s_waitcnt vmcnt(3)
  s_barrier
  s_cmp_lg_u32 s48, 0
  s_cbranch_scc1 F_nop2
  s_lshl_b32 s70, s2, 3
  s_add_u32 s70, s70, 24248320
  v_mov_b32 v100, s86
  v_mov_b32 v101, s87
  v_lshlrev_b32 v102, 11, v2
  s_mov_b64 exec, 65535
  buffer_store_dwordx2 v[100:101], v102, s[32:35], s70 offen sc1
  s_mov_b64 exec, -1
F_nop2:
  s_cmp_eq_u64 s[96:97], 0
  s_cbranch_scc1 F_pr5
  s_setprio 1
F_pr5:
  v_exp_f32 v32, v32
  v_exp_f32 v33, v33
  s_waitcnt lgkmcnt(3)
  v_smfmac_f32_32x32x32_bf16 v[80:95], v[20:23], v[56:63], v28
  ds_read_b64_tr_b16 v[20:21], v98 offset:33024
  ds_read_b64_tr_b16 v[22:23], v99 offset:33024
  v_exp_f32 v34, v34
  v_exp_f32 v35, v35
  v_exp_f32 v36, v36
  v_exp_f32 v37, v37
  s_waitcnt lgkmcnt(4)
  v_mfma_f32_32x32x16_bf16 v[48:63], v[12:15], v[8:11], v[64:79]
  ds_read_b128 v[12:15], v5 offset:37152
  v_exp_f32 v38, v38
  v_exp_f32 v39, v39
  s_add_u32 m0, s9, 115584
  s_add_u32 s62, s8, 57344
  buffer_load_dwordx4 v3, s[32:35], s62 offen lds
  v_exp_f32 v40, v40
  v_exp_f32 v41, v41
  s_waitcnt lgkmcnt(3)
  v_smfmac_f32_32x32x32_bf16 v[80:95], v[16:19], v[32:39], v28
  ds_read_b64_tr_b16 v[16:17], v96 offset:35088
  ds_read_b64_tr_b16 v[18:19], v97 offset:35088
  v_exp_f32 v42, v42
  v_exp_f32 v43, v43
  v_exp_f32 v44, v44
  v_exp_f32 v45, v45
  v_exp_f32 v46, v46
  v_exp_f32 v47, v47
  v_exp_f32 v48, v48
  v_exp_f32 v49, v49
  s_waitcnt lgkmcnt(3)
  v_smfmac_f32_32x32x32_bf16 v[80:95], v[20:23], v[40:47], v28
  ds_read_b64_tr_b16 v[20:21], v98 offset:35088
  ds_read_b64_tr_b16 v[22:23], v99 offset:35088
  v_exp_f32 v50, v50
  v_exp_f32 v51, v51
  v_exp_f32 v52, v52
  v_exp_f32 v53, v53
  s_waitcnt lgkmcnt(4)
  v_mfma_f32_32x32x16_bf16 v[32:47], v[12:15], v[8:11], v[64:79]
  ds_read_b128 v[12:15], v5 offset:39216
  v_exp_f32 v54, v54
  v_exp_f32 v55, v55
  s_add_u32 m0, s9, 123840
  s_add_u32 s62, s8, 61440
  buffer_load_dwordx4 v3, s[32:35], s62 offen lds
  v_exp_f32 v56, v56
  v_exp_f32 v57, v57
  s_waitcnt lgkmcnt(3)
  v_smfmac_f32_32x32x32_bf16 v[80:95], v[16:19], v[48:55], v28
  ds_read_b64_tr_b16 v[16:17], v96 offset:37152
  ds_read_b64_tr_b16 v[18:19], v97 offset:37152
  v_exp_f32 v58, v58
  v_exp_f32 v59, v59
  v_exp_f32 v60, v60
  v_exp_f32 v61, v61
  v_exp_f32 v62, v62
  v_exp_f32 v63, v63
  v_exp_f32 v32, v32
  v_exp_f32 v33, v33
  s_waitcnt lgkmcnt(3)
  v_smfmac_f32_32x32x32_bf16 v[80:95], v[20:23], v[56:63], v28
  ds_read_b64_tr_b16 v[20:21], v98 offset:37152
  ds_read_b64_tr_b16 v[22:23], v99 offset:37152
  v_exp_f32 v34, v34
  v_exp_f32 v35, v35
  v_exp_f32 v36, v36
  v_exp_f32 v37, v37
  s_waitcnt lgkmcnt(4)
  v_mfma_f32_32x32x16_bf16 v[48:63], v[12:15], v[8:11], v[64:79]
  ds_read_b128 v[12:15], v5 offset:41280
  v_exp_f32 v38, v38
  v_exp_f32 v39, v39
  v_exp_f32 v40, v40
  v_exp_f32 v41, v41
  s_waitcnt lgkmcnt(3)
  v_smfmac_f32_32x32x32_bf16 v[80:95], v[16:19], v[32:39], v28
  ds_read_b64_tr_b16 v[16:17], v96 offset:39216
  ds_read_b64_tr_b16 v[18:19], v97 offset:39216
  v_exp_f32 v42, v42
  v_exp_f32 v43, v43
  v_exp_f32 v44, v44
  v_exp_f32 v45, v45
  v_exp_f32 v46, v46
  v_exp_f32 v47, v47
  v_exp_f32 v48, v48
  v_exp_f32 v49, v49
  s_waitcnt lgkmcnt(3)
  v_smfmac_f32_32x32x32_bf16 v[80:95], v[20:23], v[40:47], v28
  ds_read_b64_tr_b16 v[20:21], v98 offset:39216
  ds_read_b64_tr_b16 v[22:23], v99 offset:39216
  v_exp_f32 v50, v50
  v_exp_f32 v51, v51
  v_exp_f32 v52, v52
  v_exp_f32 v53, v53
  s_waitcnt lgkmcnt(4)
  v_mfma_f32_32x32x16_bf16 v[32:47], v[12:15], v[8:11], v[64:79]
  ds_read_b128 v[12:15], v5 offset:43344
  v_exp_f32 v54, v54
  v_exp_f32 v55, v55
  v_exp_f32 v56, v56
  v_exp_f32 v57, v57
  s_waitcnt lgkmcnt(3)
  v_smfmac_f32_32x32x32_bf16 v[80:95], v[16:19], v[48:55], v28
  ds_read_b64_tr_b16 v[16:17], v96 offset:41280
  ds_read_b64_tr_b16 v[18:19], v97 offset:41280
  v_exp_f32 v58, v58
  v_exp_f32 v59, v59
  v_exp_f32 v60, v60
  v_exp_f32 v61, v61
  v_exp_f32 v62, v62
  v_exp_f32 v63, v63
  v_exp_f32 v32, v32
  v_exp_f32 v33, v33
  s_waitcnt lgkmcnt(3)
  v_smfmac_f32_32x32x32_bf16 v[80:95], v[20:23], v[56:63], v28
  ds_read_b64_tr_b16 v[20:21], v98 offset:41280
  ds_read_b64_tr_b16 v[22:23], v99 offset:41280
  v_exp_f32 v34, v34
  v_exp_f32 v35, v35
  v_exp_f32 v36, v36
  v_exp_f32 v37, v37
  s_waitcnt lgkmcnt(4)
  v_mfma_f32_32x32x16_bf16 v[48:63], v[12:15], v[8:11], v[64:79]
  ds_read_b128 v[12:15], v5 offset:45408
  v_exp_f32 v38, v38
  v_exp_f32 v39, v39
  v_exp_f32 v40, v40
  v_exp_f32 v41, v41
  s_waitcnt lgkmcnt(3)
  v_smfmac_f32_32x32x32_bf16 v[80:95], v[16:19], v[32:39], v28
  ds_read_b64_tr_b16 v[16:17], v96 offset:43344
  ds_read_b64_tr_b16 v[18:19], v97 offset:43344
  v_exp_f32 v42, v42
  v_exp_f32 v43, v43
  v_exp_f32 v44, v44
  v_exp_f32 v45, v45
  v_exp_f32 v46, v46
  v_exp_f32 v47, v47
  s_cmp_eq_u64 s[96:97], 0
  s_cbranch_scc1 F_pr6
  s_setprio 0
F_pr6:
  v_exp_f32 v48, v48
  v_exp_f32 v49, v49
  s_waitcnt lgkmcnt(3)
  v_smfmac_f32_32x32x32_bf16 v[80:95], v[20:23], v[40:47], v28
  ds_read_b64_tr_b16 v[20:21], v98 offset:43344
  ds_read_b64_tr_b16 v[22:23], v99 offset:43344
  v_exp_f32 v50, v50
  v_exp_f32 v51, v51
  v_exp_f32 v52, v52
  v_exp_f32 v53, v53
  s_waitcnt lgkmcnt(4)
  v_mfma_f32_32x32x16_bf16 v[32:47], v[12:15], v[8:11], v[64:79]
  ds_read_b128 v[12:15], v5 offset:47472
  v_exp_f32 v54, v54
  v_exp_f32 v55, v55
  v_exp_f32 v56, v56
  v_exp_f32 v57, v57
  s_waitcnt lgkmcnt(3)
  v_smfmac_f32_32x32x32_bf16 v[80:95], v[16:19], v[48:55], v28
  ds_read_b64_tr_b16 v[16:17], v96 offset:45408
  ds_read_b64_tr_b16 v[18:19], v97 offset:45408
  v_exp_f32 v58, v58
  v_exp_f32 v59, v59
  v_exp_f32 v60, v60
  v_exp_f32 v61, v61
  v_exp_f32 v62, v62
  v_exp_f32 v63, v63
  v_exp_f32 v32, v32
  v_exp_f32 v33, v33
  s_waitcnt lgkmcnt(3)
  v_smfmac_f32_32x32x32_bf16 v[80:95], v[20:23], v[56:63], v28
  ds_read_b64_tr_b16 v[20:21], v98 offset:45408
  ds_read_b64_tr_b16 v[22:23], v99 offset:45408
  v_exp_f32 v34, v34
  v_exp_f32 v35, v35
  v_exp_f32 v36, v36
  v_exp_f32 v37, v37
  s_waitcnt lgkmcnt(4)
  v_mfma_f32_32x32x16_bf16 v[48:63], v[12:15], v[8:11], v[64:79]
  ds_read_b128 v[12:15], v5 offset:49536
  v_exp_f32 v38, v38
  v_exp_f32 v39, v39
  v_exp_f32 v40, v40
  v_exp_f32 v41, v41
  s_waitcnt lgkmcnt(3)
  v_smfmac_f32_32x32x32_bf16 v[80:95], v[16:19], v[32:39], v28
  ds_read_b64_tr_b16 v[16:17], v96 offset:47472
  ds_read_b64_tr_b16 v[18:19], v97 offset:47472
  v_exp_f32 v42, v42
  v_exp_f32 v43, v43
  v_exp_f32 v44, v44
  v_exp_f32 v45, v45
  s_cmp_lg_u32 s48, 1
  s_cbranch_scc1 F_p2a
  v_lshlrev_b32 v110, 5, v2
  s_and_b32 s71, s2, 15
  s_lshl_b32 s71, s71, 11
  s_add_u32 s71, s71, 24248320
  buffer_load_dwordx4 v[112:115], v110, s[32:35], s71 offen sc1
  buffer_load_dwordx4 v[116:119], v110, s[32:35], s71 offen offset:16 sc1
F_p2a:
  v_exp_f32 v46, v46
  v_exp_f32 v47, v47
  v_exp_f32 v48, v48
  v_exp_f32 v49, v49
  s_waitcnt lgkmcnt(3)
  v_smfmac_f32_32x32x32_bf16 v[80:95], v[20:23], v[40:47], v28
  ds_read_b64_tr_b16 v[20:21], v98 offset:47472
  ds_read_b64_tr_b16 v[22:23], v99 offset:47472
  v_exp_f32 v50, v50
  v_exp_f32 v51, v51
  v_exp_f32 v52, v52
  v_exp_f32 v53, v53
  s_waitcnt lgkmcnt(4)
  v_mfma_f32_32x32x16_bf16 v[32:47], v[12:15], v[8:11], v[64:79]
  ds_read_b128 v[12:15], v5 offset:51600
  v_exp_f32 v54, v54
  v_exp_f32 v55, v55
  v_exp_f32 v56, v56
  v_exp_f32 v57, v57
  s_waitcnt lgkmcnt(3)
  v_smfmac_f32_32x32x32_bf16 v[80:95], v[16:19], v[48:55], v28
  ds_read_b64_tr_b16 v[16:17], v96 offset:49536
  ds_read_b64_tr_b16 v[18:19], v97 offset:49536
  v_exp_f32 v58, v58
  v_exp_f32 v59, v59
  v_exp_f32 v60, v60
  v_exp_f32 v61, v61
  v_exp_f32 v62, v62
  v_exp_f32 v63, v63
  v_add_u32 v5, 49536, v5
  v_add_u32 v96, 49536, v96
  v_add_u32 v97, 49536, v97
  v_add_u32 v98, 49536, v98
  v_add_u32 v99, 49536, v99
  s_waitcnt vmcnt(0)
  s_cmp_lg_u32 s48, 1
  s_cbranch_scc1 F_p2_ok
  s_waitcnt vmcnt(0)
  v_cmp_eq_u64 vcc, s[86:87], v[112:113]
  v_cmp_eq_u64 s[72:73], s[86:87], v[114:115]
  v_cmp_eq_u64 s[74:75], s[86:87], v[116:117]
  v_cmp_eq_u64 s[76:77], s[86:87], v[118:119]
  s_and_b64 s[72:73], s[72:73], vcc
  s_and_b64 s[74:75], s[74:75], s[76:77]
  s_and_b64 s[72:73], s[72:73], s[74:75]
  s_cmp_eq_u64 s[72:73], exec
  s_cbranch_scc1 F_p2_ok
  s_mov_b32 s79, 32768
F_p2_retry:
  s_sleep 2
  buffer_load_dwordx4 v[112:115], v110, s[32:35], s71 offen sc1
  buffer_load_dwordx4 v[116:119], v110, s[32:35], s71 offen offset:16 sc1
  s_waitcnt vmcnt(0)
  v_cmp_eq_u64 vcc, s[86:87], v[112:113]
  v_cmp_eq_u64 s[72:73], s[86:87], v[114:115]
  v_cmp_eq_u64 s[74:75], s[86:87], v[116:117]
  v_cmp_eq_u64 s[76:77], s[86:87], v[118:119]
  s_and_b64 s[72:73], s[72:73], vcc
  s_and_b64 s[74:75], s[74:75], s[76:77]
  s_and_b64 s[72:73], s[72:73], s[74:75]
  s_cmp_eq_u64 s[72:73], exec
  s_cbranch_scc1 F_p2_ok
  s_sub_u32 s79, s79, 1
  s_cmp_lg_u32 s79, 0
  s_cbranch_scc1 F_p2_retry
F_p2_ok:
  s_barrier
  v_and_b32 v100, 31, v2
  v_lshlrev_b32 v100, 2, v100
  buffer_load_dword v6, v100, s[32:35], s17 offen
  buffer_load_dword v7, v100, s[32:35], s18 offen
  s_cmp_eq_u64 s[96:97], 0
  s_cbranch_scc1 F_pr7
  s_setprio 1
F_pr7:
  v_exp_f32 v32, v32
  v_exp_f32 v33, v33
  s_waitcnt lgkmcnt(3)
  v_smfmac_f32_32x32x32_bf16 v[80:95], v[20:23], v[56:63], v28
  ds_read_b64_tr_b16 v[20:21], v98 offset:0
  ds_read_b64_tr_b16 v[22:23], v99 offset:0
  v_exp_f32 v34, v34
  v_exp_f32 v35, v35
  v_exp_f32 v36, v36
  v_exp_f32 v37, v37
  s_waitcnt lgkmcnt(4)
  v_mfma_f32_32x32x16_bf16 v[48:63], v[12:15], v[8:11], v[64:79]
  ds_read_b128 v[12:15], v5 offset:4128
  buffer_load_dwordx4 v[116:119], v3, s[32:35], s14 offen offset:0
  v_exp_f32 v38, v38
  v_exp_f32 v39, v39
  v_exp_f32 v40, v40
  v_exp_f32 v41, v41
  s_waitcnt lgkmcnt(3)
  v_smfmac_f32_32x32x32_bf16 v[80:95], v[16:19], v[32:39], v28
  ds_read_b64_tr_b16 v[16:17], v96 offset:2064
  ds_read_b64_tr_b16 v[18:19], v97 offset:2064
  v_exp_f32 v42, v42
  v_exp_f32 v43, v43
  v_exp_f32 v44, v44
  v_exp_f32 v45, v45
  buffer_load_dwordx4 v[120:123], v3, s[32:35], s16 offen offset:0
  buffer_load_dwordx4 v[112:115], v3, s[32:35], s15 offen offset:0
  v_exp_f32 v46, v46
  v_exp_f32 v47, v47
  v_exp_f32 v48, v48
  v_exp_f32 v49, v49
  s_waitcnt lgkmcnt(3)
  v_smfmac_f32_32x32x32_bf16 v[80:95], v[20:23], v[40:47], v28
  ds_read_b64_tr_b16 v[20:21], v98 offset:2064
  ds_read_b64_tr_b16 v[22:23], v99 offset:2064
  v_exp_f32 v50, v50
  v_exp_f32 v51, v51
  v_exp_f32 v52, v52
  v_exp_f32 v53, v53
  s_waitcnt lgkmcnt(4)
  v_mfma_f32_32x32x16_bf16 v[32:47], v[12:15], v[8:11], v[64:79]
  ds_read_b128 v[12:15], v5 offset:6192
  buffer_load_dwordx4 v[128:131], v3, s[32:35], s14 offen offset:1024
  v_exp_f32 v54, v54
  v_exp_f32 v55, v55
  v_exp_f32 v56, v56
  v_exp_f32 v57, v57
  s_waitcnt lgkmcnt(3)
  v_smfmac_f32_32x32x32_bf16 v[80:95], v[16:19], v[48:55], v28
  ds_read_b64_tr_b16 v[16:17], v96 offset:4128
  ds_read_b64_tr_b16 v[18:19], v97 offset:4128
  v_exp_f32 v58, v58
  v_exp_f32 v59, v59
  v_exp_f32 v60, v60
  v_exp_f32 v61, v61
  buffer_load_dwordx4 v[132:135], v3, s[32:35], s16 offen offset:1024
  buffer_load_dwordx4 v[124:127], v3, s[32:35], s15 offen offset:1024
  v_exp_f32 v62, v62
  v_exp_f32 v63, v63
  v_exp_f32 v32, v32
  v_exp_f32 v33, v33
  s_waitcnt lgkmcnt(3)
  v_smfmac_f32_32x32x32_bf16 v[80:95], v[20:23], v[56:63], v28
  ds_read_b64_tr_b16 v[20:21], v98 offset:4128
  ds_read_b64_tr_b16 v[22:23], v99 offset:4128
  v_exp_f32 v34, v34
  v_exp_f32 v35, v35
  v_exp_f32 v36, v36
  v_exp_f32 v37, v37
  s_waitcnt lgkmcnt(4)
  v_mfma_f32_32x32x16_bf16 v[48:63], v[12:15], v[8:11], v[64:79]
  ds_read_b128 v[12:15], v5 offset:8256
  buffer_load_dwordx4 v[140:143], v3, s[32:35], s14 offen offset:2048
  v_exp_f32 v38, v38
  v_exp_f32 v39, v39
  v_exp_f32 v40, v40
  v_exp_f32 v41, v41
  s_waitcnt lgkmcnt(3)
  v_smfmac_f32_32x32x32_bf16 v[80:95], v[16:19], v[32:39], v28
  ds_read_b64_tr_b16 v[16:17], v96 offset:6192
  ds_read_b64_tr_b16 v[18:19], v97 offset:6192
  v_exp_f32 v42, v42
  v_exp_f32 v43, v43
  v_exp_f32 v44, v44
  v_exp_f32 v45, v45
  buffer_load_dwordx4 v[144:147], v3, s[32:35], s16 offen offset:2048
  buffer_load_dwordx4 v[136:139], v3, s[32:35], s15 offen offset:2048
  v_exp_f32 v46, v46
  v_exp_f32 v47, v47
  v_exp_f32 v48, v48
  v_exp_f32 v49, v49
  s_waitcnt lgkmcnt(3)
  v_smfmac_f32_32x32x32_bf16 v[80:95], v[20:23], v[40:47], v28
  ds_read_b64_tr_b16 v[20:21], v98 offset:6192
  ds_read_b64_tr_b16 v[22:23], v99 offset:6192
  v_exp_f32 v50, v50
  v_exp_f32 v51, v51
  v_exp_f32 v52, v52
  v_exp_f32 v53, v53
  s_waitcnt lgkmcnt(4)
  v_mfma_f32_32x32x16_bf16 v[32:47], v[12:15], v[8:11], v[64:79]
  ds_read_b128 v[12:15], v5 offset:10320
  buffer_load_dwordx4 v[152:155], v3, s[32:35], s14 offen offset:3072
  v_exp_f32 v54, v54
  v_exp_f32 v55, v55
  v_exp_f32 v56, v56
  v_exp_f32 v57, v57
  s_waitcnt lgkmcnt(3)
  v_smfmac_f32_32x32x32_bf16 v[80:95], v[16:19], v[48:55], v28
  ds_read_b64_tr_b16 v[16:17], v96 offset:8256
  ds_read_b64_tr_b16 v[18:19], v97 offset:8256
  v_exp_f32 v58, v58
  v_exp_f32 v59, v59
  v_exp_f32 v60, v60
  v_exp_f32 v61, v61
  buffer_load_dwordx4 v[156:159], v3, s[32:35], s16 offen offset:3072
  buffer_load_dwordx4 v[148:151], v3, s[32:35], s15 offen offset:3072
  v_exp_f32 v62, v62
  v_exp_f32 v63, v63
  v_exp_f32 v32, v32
  v_exp_f32 v33, v33
  s_waitcnt lgkmcnt(3)
  v_smfmac_f32_32x32x32_bf16 v[80:95], v[20:23], v[56:63], v28
  ds_read_b64_tr_b16 v[20:21], v98 offset:8256
  ds_read_b64_tr_b16 v[22:23], v99 offset:8256
  v_exp_f32 v34, v34
  v_exp_f32 v35, v35
  v_exp_f32 v36, v36
  v_exp_f32 v37, v37
  s_waitcnt lgkmcnt(4)
  v_mfma_f32_32x32x16_bf16 v[48:63], v[12:15], v[8:11], v[64:79]
  ds_read_b128 v[12:15], v5 offset:12384
  v_exp_f32 v38, v38
  v_exp_f32 v39, v39
  v_exp_f32 v40, v40
  v_exp_f32 v41, v41
  s_waitcnt lgkmcnt(3)
  v_smfmac_f32_32x32x32_bf16 v[80:95], v[16:19], v[32:39], v28
  ds_read_b64_tr_b16 v[16:17], v96 offset:10320
  ds_read_b64_tr_b16 v[18:19], v97 offset:10320
  v_exp_f32 v42, v42
  v_exp_f32 v43, v43
  v_exp_f32 v44, v44
  v_exp_f32 v45, v45
  s_waitcnt vmcnt(9)
  v_mfma_f32_32x32x16_bf16 v[176:191], v[116:119], v[112:115], 0
  s_add_u32 s14, s14, 4096
  buffer_load_dwordx4 v[116:119], v3, s[32:35], s14 offen offset:0
  v_exp_f32 v46, v46
  v_exp_f32 v47, v47
  s_cmp_eq_u64 s[96:97], 0
  s_cbranch_scc1 F_pr8
  s_setprio 0
F_pr8:
  v_exp_f32 v48, v48
  v_exp_f32 v49, v49
  s_waitcnt lgkmcnt(3)
  v_smfmac_f32_32x32x32_bf16 v[80:95], v[20:23], v[40:47], v28
  ds_read_b64_tr_b16 v[20:21], v98 offset:10320
  ds_read_b64_tr_b16 v[22:23], v99 offset:10320
  v_exp_f32 v50, v50
  v_exp_f32 v51, v51
  v_exp_f32 v52, v52
  v_exp_f32 v53, v53
  s_waitcnt lgkmcnt(4)
  v_mfma_f32_32x32x16_bf16 v[32:47], v[12:15], v[8:11], v[64:79]
  ds_read_b128 v[12:15], v5 offset:14448
  buffer_load_dwordx4 v[192:195], v3, s[32:35], s98 offen offset:0
  v_exp_f32 v54, v54
  v_exp_f32 v55, v55
  v_exp_f32 v56, v56
  v_exp_f32 v57, v57
  s_waitcnt lgkmcnt(3)
  v_smfmac_f32_32x32x32_bf16 v[80:95], v[16:19], v[48:55], v28
  ds_read_b64_tr_b16 v[16:17], v96 offset:12384
  ds_read_b64_tr_b16 v[18:19], v97 offset:12384
  v_exp_f32 v58, v58
  v_exp_f32 v59, v59
  v_exp_f32 v60, v60
  v_exp_f32 v61, v61
  v_mfma_f32_32x32x16_bf16 v[160:175], v[120:123], v[112:115], 0
  s_add_u32 s16, s16, 4096
  buffer_load_dwordx4 v[120:123], v3, s[32:35], s16 offen offset:0
  s_add_u32 s15, s15, 4096
  buffer_load_dwordx4 v[112:115], v3, s[32:35], s15 offen offset:0
  v_exp_f32 v62, v62
  v_exp_f32 v63, v63
  v_exp_f32 v32, v32
  v_exp_f32 v33, v33
  s_waitcnt lgkmcnt(3)
  v_smfmac_f32_32x32x32_bf16 v[80:95], v[20:23], v[56:63], v28
  ds_read_b64_tr_b16 v[20:21], v98 offset:12384
  ds_read_b64_tr_b16 v[22:23], v99 offset:12384
  v_exp_f32 v34, v34
  v_exp_f32 v35, v35
  v_exp_f32 v36, v36
  v_exp_f32 v37, v37
  s_waitcnt lgkmcnt(4)
  v_mfma_f32_32x32x16_bf16 v[48:63], v[12:15], v[8:11], v[64:79]
  ds_read_b128 v[12:15], v5 offset:16512
  v_exp_f32 v38, v38
  v_exp_f32 v39, v39
  v_exp_f32 v40, v40
  v_exp_f32 v41, v41
  s_waitcnt lgkmcnt(3)
  v_smfmac_f32_32x32x32_bf16 v[80:95], v[16:19], v[32:39], v28
  ds_read_b64_tr_b16 v[16:17], v96 offset:14448
  ds_read_b64_tr_b16 v[18:19], v97 offset:14448
  v_exp_f32 v42, v42
  v_exp_f32 v43, v43
  v_exp_f32 v44, v44
  v_exp_f32 v45, v45
  s_waitcnt vmcnt(10)
  v_mfma_f32_32x32x16_bf16 v[176:191], v[128:131], v[124:127], v[176:191]
  buffer_load_dwordx4 v[128:131], v3, s[32:35], s14 offen offset:1024
  v_exp_f32 v46, v46
  v_exp_f32 v47, v47
  v_exp_f32 v48, v48
  v_exp_f32 v49, v49
  s_waitcnt lgkmcnt(3)
  v_smfmac_f32_32x32x32_bf16 v[80:95], v[20:23], v[40:47], v28
  ds_read_b64_tr_b16 v[20:21], v98 offset:14448
  ds_read_b64_tr_b16 v[22:23], v99 offset:14448
  v_exp_f32 v50, v50
  v_exp_f32 v51, v51
  v_exp_f32 v52, v52
  v_exp_f32 v53, v53
  s_waitcnt lgkmcnt(4)
  v_mfma_f32_32x32x16_bf16 v[32:47], v[12:15], v[8:11], v[64:79]
  ds_read_b128 v[12:15], v5 offset:18576
  buffer_load_dwordx4 v[196:199], v3, s[32:35], s99 offen offset:0
  v_exp_f32 v54, v54
  v_exp_f32 v55, v55
  v_mfma_f32_32x32x16_bf16 v[160:175], v[132:135], v[124:127], v[160:175]
  buffer_load_dwordx4 v[132:135], v3, s[32:35], s16 offen offset:1024
  buffer_load_dwordx4 v[124:127], v3, s[32:35], s15 offen offset:1024
  v_exp_f32 v56, v56
  v_exp_f32 v57, v57
  s_waitcnt lgkmcnt(3)
  v_smfmac_f32_32x32x32_bf16 v[80:95], v[16:19], v[48:55], v28
  ds_read_b64_tr_b16 v[16:17], v96 offset:16512
  ds_read_b64_tr_b16 v[18:19], v97 offset:16512
  v_exp_f32 v58, v58
  v_exp_f32 v59, v59
  v_exp_f32 v60, v60
  v_exp_f32 v61, v61
  s_waitcnt vmcnt(11)
  v_mfma_f32_32x32x16_bf16 v[176:191], v[140:143], v[136:139], v[176:191]
  buffer_load_dwordx4 v[140:143], v3, s[32:35], s14 offen offset:2048
  v_exp_f32 v62, v62
  v_exp_f32 v63, v63
  s_cmp_eq_u64 s[96:97], 0
  s_cbranch_scc1 F_pr9
  s_setprio 1
F_pr9:
  v_exp_f32 v32, v32
  v_exp_f32 v33, v33
  s_waitcnt lgkmcnt(3)
  v_smfmac_f32_32x32x32_bf16 v[80:95], v[20:23], v[56:63], v28
  ds_read_b64_tr_b16 v[20:21], v98 offset:16512
  ds_read_b64_tr_b16 v[22:23], v99 offset:16512
  v_exp_f32 v34, v34
  v_exp_f32 v35, v35
  v_exp_f32 v36, v36
  v_exp_f32 v37, v37
  s_waitcnt lgkmcnt(4)
  v_mfma_f32_32x32x16_bf16 v[48:63], v[12:15], v[8:11], v[64:79]
  ds_read_b128 v[12:15], v5 offset:20640
  v_exp_f32 v38, v38
  v_exp_f32 v39, v39
  v_exp_f32 v40, v40
  v_exp_f32 v41, v41
  s_waitcnt lgkmcnt(3)
  v_smfmac_f32_32x32x32_bf16 v[80:95], v[16:19], v[32:39], v28
  ds_read_b64_tr_b16 v[16:17], v96 offset:18576
  ds_read_b64_tr_b16 v[18:19], v97 offset:18576
  v_exp_f32 v42, v42
  v_exp_f32 v43, v43
  v_exp_f32 v44, v44
  v_exp_f32 v45, v45
  v_mfma_f32_32x32x16_bf16 v[160:175], v[144:147], v[136:139], v[160:175]
  buffer_load_dwordx4 v[144:147], v3, s[32:35], s16 offen offset:2048
  buffer_load_dwordx4 v[136:139], v3, s[32:35], s15 offen offset:2048
  v_exp_f32 v46, v46
  v_exp_f32 v47, v47
  v_exp_f32 v48, v48
  v_exp_f32 v49, v49
  s_waitcnt lgkmcnt(3)
  v_smfmac_f32_32x32x32_bf16 v[80:95], v[20:23], v[40:47], v28
  ds_read_b64_tr_b16 v[20:21], v98 offset:18576
  ds_read_b64_tr_b16 v[22:23], v99 offset:18576
  v_exp_f32 v50, v50
  v_exp_f32 v51, v51
  v_exp_f32 v52, v52
  v_exp_f32 v53, v53
  s_waitcnt lgkmcnt(4)
  v_mfma_f32_32x32x16_bf16 v[32:47], v[12:15], v[8:11], v[64:79]
  ds_read_b128 v[12:15], v5 offset:22704
  buffer_load_dwordx4 v[200:203], v3, s[32:35], s98 offen offset:1024
  v_exp_f32 v54, v54
  v_exp_f32 v55, v55
  v_exp_f32 v56, v56
  v_exp_f32 v57, v57
  s_waitcnt lgkmcnt(3)
  v_smfmac_f32_32x32x32_bf16 v[80:95], v[16:19], v[48:55], v28
  ds_read_b64_tr_b16 v[16:17], v96 offset:20640
  ds_read_b64_tr_b16 v[18:19], v97 offset:20640
  v_exp_f32 v58, v58
  v_exp_f32 v59, v59
  v_exp_f32 v60, v60
  v_exp_f32 v61, v61
  s_waitcnt vmcnt(12)
  v_mfma_f32_32x32x16_bf16 v[176:191], v[152:155], v[148:151], v[176:191]
  buffer_load_dwordx4 v[152:155], v3, s[32:35], s14 offen offset:3072
  v_exp_f32 v62, v62
  v_exp_f32 v63, v63
  v_exp_f32 v32, v32
  v_exp_f32 v33, v33
  s_waitcnt lgkmcnt(3)
  v_smfmac_f32_32x32x32_bf16 v[80:95], v[20:23], v[56:63], v28
  ds_read_b64_tr_b16 v[20:21], v98 offset:20640
  ds_read_b64_tr_b16 v[22:23], v99 offset:20640
  v_exp_f32 v34, v34
  v_exp_f32 v35, v35
  v_exp_f32 v36, v36
  v_exp_f32 v37, v37
  s_waitcnt lgkmcnt(4)
  v_mfma_f32_32x32x16_bf16 v[48:63], v[12:15], v[8:11], v[64:79]
  ds_read_b128 v[12:15], v5 offset:24768
  v_exp_f32 v38, v38
  v_exp_f32 v39, v39
  v_mfma_f32_32x32x16_bf16 v[160:175], v[156:159], v[148:151], v[160:175]
  buffer_load_dwordx4 v[156:159], v3, s[32:35], s16 offen offset:3072
  buffer_load_dwordx4 v[148:151], v3, s[32:35], s15 offen offset:3072
  v_exp_f32 v40, v40
  v_exp_f32 v41, v41
  s_waitcnt lgkmcnt(3)
  v_smfmac_f32_32x32x32_bf16 v[80:95], v[16:19], v[32:39], v28
  ds_read_b64_tr_b16 v[16:17], v96 offset:22704
  ds_read_b64_tr_b16 v[18:19], v97 offset:22704
  v_exp_f32 v42, v42
  v_exp_f32 v43, v43
  v_exp_f32 v44, v44
  v_exp_f32 v45, v45
  s_waitcnt vmcnt(11)
  v_mfma_f32_32x32x16_bf16 v[176:191], v[116:119], v[112:115], v[176:191]
  s_add_u32 s14, s14, 4096
  buffer_load_dwordx4 v[116:119], v3, s[32:35], s14 offen offset:0
  v_exp_f32 v46, v46
  v_exp_f32 v47, v47
  v_exp_f32 v48, v48
  v_exp_f32 v49, v49
  s_waitcnt lgkmcnt(3)
  v_smfmac_f32_32x32x32_bf16 v[80:95], v[20:23], v[40:47], v28
  ds_read_b64_tr_b16 v[20:21], v98 offset:22704
  ds_read_b64_tr_b16 v[22:23], v99 offset:22704
  v_exp_f32 v50, v50
  v_exp_f32 v51, v51
  v_exp_f32 v52, v52
  v_exp_f32 v53, v53
  s_waitcnt lgkmcnt(4)
  v_mfma_f32_32x32x16_bf16 v[32:47], v[12:15], v[8:11], v[64:79]
  ds_read_b128 v[12:15], v5 offset:26832
  buffer_load_dwordx4 v[204:207], v3, s[32:35], s99 offen offset:1024
  v_exp_f32 v54, v54
  v_exp_f32 v55, v55
  v_exp_f32 v56, v56
  v_exp_f32 v57, v57
  s_waitcnt lgkmcnt(3)
  v_smfmac_f32_32x32x32_bf16 v[80:95], v[16:19], v[48:55], v28
  ds_read_b64_tr_b16 v[16:17], v96 offset:24768
  ds_read_b64_tr_b16 v[18:19], v97 offset:24768
  v_exp_f32 v58, v58
  v_exp_f32 v59, v59
  v_exp_f32 v60, v60
  v_exp_f32 v61, v61
  v_mfma_f32_32x32x16_bf16 v[160:175], v[120:123], v[112:115], v[160:175]
  s_add_u32 s16, s16, 4096
  buffer_load_dwordx4 v[120:123], v3, s[32:35], s16 offen offset:0
  s_add_u32 s15, s15, 4096
  buffer_load_dwordx4 v[112:115], v3, s[32:35], s15 offen offset:0
  v_exp_f32 v62, v62
  v_exp_f32 v63, v63
  v_exp_f32 v32, v32
  v_exp_f32 v33, v33
  s_waitcnt lgkmcnt(3)
  v_smfmac_f32_32x32x32_bf16 v[80:95], v[20:23], v[56:63], v28
  ds_read_b64_tr_b16 v[20:21], v98 offset:24768
  ds_read_b64_tr_b16 v[22:23], v99 offset:24768
  v_exp_f32 v34, v34
  v_exp_f32 v35, v35
  v_exp_f32 v36, v36
  v_exp_f32 v37, v37
  s_waitcnt lgkmcnt(4)
  v_mfma_f32_32x32x16_bf16 v[48:63], v[12:15], v[8:11], v[64:79]
  ds_read_b128 v[12:15], v5 offset:28896
  v_exp_f32 v38, v38
  v_exp_f32 v39, v39
  v_exp_f32 v40, v40
  v_exp_f32 v41, v41
  s_waitcnt lgkmcnt(3)
  v_smfmac_f32_32x32x32_bf16 v[80:95], v[16:19], v[32:39], v28
  ds_read_b64_tr_b16 v[16:17], v96 offset:26832
  ds_read_b64_tr_b16 v[18:19], v97 offset:26832
  v_exp_f32 v42, v42
  v_exp_f32 v43, v43
  v_exp_f32 v44, v44
  v_exp_f32 v45, v45
  s_waitcnt vmcnt(11)
  v_mfma_f32_32x32x16_bf16 v[176:191], v[128:131], v[124:127], v[176:191]
  buffer_load_dwordx4 v[128:131], v3, s[32:35], s14 offen offset:1024
  v_exp_f32 v46, v46
  v_exp_f32 v47, v47
  s_cmp_eq_u64 s[96:97], 0
  s_cbranch_scc1 F_pr10
  s_setprio 0
F_pr10:
  v_exp_f32 v48, v48
  v_exp_f32 v49, v49
  s_waitcnt lgkmcnt(3)
  v_smfmac_f32_32x32x32_bf16 v[80:95], v[20:23], v[40:47], v28
  ds_read_b64_tr_b16 v[20:21], v98 offset:26832
  ds_read_b64_tr_b16 v[22:23], v99 offset:26832
  v_exp_f32 v50, v50
  v_exp_f32 v51, v51
  v_exp_f32 v52, v52
  v_exp_f32 v53, v53
  s_waitcnt lgkmcnt(4)
  v_mfma_f32_32x32x16_bf16 v[32:47], v[12:15], v[8:11], v[64:79]
  ds_read_b128 v[12:15], v5 offset:30960
  buffer_load_dwordx4 v[208:211], v3, s[32:35], s98 offen offset:2048
  v_exp_f32 v54, v54
  v_exp_f32 v55, v55
  v_mfma_f32_32x32x16_bf16 v[160:175], v[132:135], v[124:127], v[160:175]
  buffer_load_dwordx4 v[132:135], v3, s[32:35], s16 offen offset:1024
  buffer_load_dwordx4 v[124:127], v3, s[32:35], s15 offen offset:1024
  v_exp_f32 v56, v56
  v_exp_f32 v57, v57
  s_waitcnt lgkmcnt(3)
  v_smfmac_f32_32x32x32_bf16 v[80:95], v[16:19], v[48:55], v28
  ds_read_b64_tr_b16 v[16:17], v96 offset:28896
  ds_read_b64_tr_b16 v[18:19], v97 offset:28896
  v_exp_f32 v58, v58
  v_exp_f32 v59, v59
  v_exp_f32 v60, v60
  v_exp_f32 v61, v61
  s_waitcnt vmcnt(12)
  v_mfma_f32_32x32x16_bf16 v[176:191], v[140:143], v[136:139], v[176:191]
  buffer_load_dwordx4 v[140:143], v3, s[32:35], s14 offen offset:2048
  v_exp_f32 v62, v62
  v_exp_f32 v63, v63
  v_exp_f32 v32, v32
  v_exp_f32 v33, v33
  s_waitcnt lgkmcnt(3)
  v_smfmac_f32_32x32x32_bf16 v[80:95], v[20:23], v[56:63], v28
  ds_read_b64_tr_b16 v[20:21], v98 offset:28896
  ds_read_b64_tr_b16 v[22:23], v99 offset:28896
  v_exp_f32 v34, v34
  v_exp_f32 v35, v35
  v_exp_f32 v36, v36
  v_exp_f32 v37, v37
  s_waitcnt lgkmcnt(4)
  v_mfma_f32_32x32x16_bf16 v[48:63], v[12:15], v[8:11], v[64:79]
  ds_read_b128 v[12:15], v5 offset:33024
  v_exp_f32 v38, v38
  v_exp_f32 v39, v39
  v_exp_f32 v40, v40
  v_exp_f32 v41, v41
  s_waitcnt lgkmcnt(3)
  v_smfmac_f32_32x32x32_bf16 v[80:95], v[16:19], v[32:39], v28
  ds_read_b64_tr_b16 v[16:17], v96 offset:30960
  ds_read_b64_tr_b16 v[18:19], v97 offset:30960
  v_exp_f32 v42, v42
  v_exp_f32 v43, v43
  v_exp_f32 v44, v44
  v_exp_f32 v45, v45
  v_mfma_f32_32x32x16_bf16 v[160:175], v[144:147], v[136:139], v[160:175]
  buffer_load_dwordx4 v[144:147], v3, s[32:35], s16 offen offset:2048
  buffer_load_dwordx4 v[136:139], v3, s[32:35], s15 offen offset:2048
  v_exp_f32 v46, v46
  v_exp_f32 v47, v47
  v_exp_f32 v48, v48
  v_exp_f32 v49, v49
  s_waitcnt lgkmcnt(3)
  v_smfmac_f32_32x32x32_bf16 v[80:95], v[20:23], v[40:47], v28
  ds_read_b64_tr_b16 v[20:21], v98 offset:30960
  ds_read_b64_tr_b16 v[22:23], v99 offset:30960
  v_exp_f32 v50, v50
  v_exp_f32 v51, v51
  v_exp_f32 v52, v52
  v_exp_f32 v53, v53
  s_waitcnt lgkmcnt(4)
  v_mfma_f32_32x32x16_bf16 v[32:47], v[12:15], v[8:11], v[64:79]
  ds_read_b128 v[12:15], v5 offset:35088
  buffer_load_dwordx4 v[212:215], v3, s[32:35], s99 offen offset:2048
  v_exp_f32 v54, v54
  v_exp_f32 v55, v55
  s_waitcnt vmcnt(12)
  v_mfma_f32_32x32x16_bf16 v[176:191], v[152:155], v[148:151], v[176:191]
  buffer_load_dwordx4 v[152:155], v3, s[32:35], s14 offen offset:3072
  v_exp_f32 v56, v56
  v_exp_f32 v57, v57
  s_waitcnt lgkmcnt(3)
  v_smfmac_f32_32x32x32_bf16 v[80:95], v[16:19], v[48:55], v28
  ds_read_b64_tr_b16 v[16:17], v96 offset:33024
  ds_read_b64_tr_b16 v[18:19], v97 offset:33024
  v_exp_f32 v58, v58
  v_exp_f32 v59, v59
  v_exp_f32 v60, v60
  v_exp_f32 v61, v61
  v_mfma_f32_32x32x16_bf16 v[160:175], v[156:159], v[148:151], v[160:175]
  buffer_load_dwordx4 v[156:159], v3, s[32:35], s16 offen offset:3072
  buffer_load_dwordx4 v[148:151], v3, s[32:35], s15 offen offset:3072
  v_exp_f32 v62, v62
  v_exp_f32 v63, v63
  s_cmp_eq_u64 s[96:97], 0
  s_cbranch_scc1 F_pr11
  s_setprio 1
F_pr11:
  v_exp_f32 v32, v32
  v_exp_f32 v33, v33
  s_waitcnt lgkmcnt(3)
  v_smfmac_f32_32x32x32_bf16 v[80:95], v[20:23], v[56:63], v28
  ds_read_b64_tr_b16 v[20:21], v98 offset:33024
  ds_read_b64_tr_b16 v[22:23], v99 offset:33024
  v_exp_f32 v34, v34
  v_exp_f32 v35, v35
  v_exp_f32 v36, v36
  v_exp_f32 v37, v37
  s_waitcnt lgkmcnt(4)
  v_mfma_f32_32x32x16_bf16 v[48:63], v[12:15], v[8:11], v[64:79]
  ds_read_b128 v[12:15], v5 offset:37152
  v_exp_f32 v38, v38
  v_exp_f32 v39, v39
  v_exp_f32 v40, v40
  v_exp_f32 v41, v41
  s_waitcnt lgkmcnt(3)
  v_smfmac_f32_32x32x32_bf16 v[80:95], v[16:19], v[32:39], v28
  ds_read_b64_tr_b16 v[16:17], v96 offset:35088
  ds_read_b64_tr_b16 v[18:19], v97 offset:35088
  v_exp_f32 v42, v42
  v_exp_f32 v43, v43
  v_exp_f32 v44, v44
  v_exp_f32 v45, v45
  s_waitcnt vmcnt(11)
  v_mfma_f32_32x32x16_bf16 v[176:191], v[116:119], v[112:115], v[176:191]
  s_add_u32 s14, s14, 4096
  buffer_load_dwordx4 v[116:119], v3, s[32:35], s14 offen offset:0
  v_exp_f32 v46, v46
  v_exp_f32 v47, v47
  v_exp_f32 v48, v48
  v_exp_f32 v49, v49
  s_waitcnt lgkmcnt(3)
  v_smfmac_f32_32x32x32_bf16 v[80:95], v[20:23], v[40:47], v28
  ds_read_b64_tr_b16 v[20:21], v98 offset:35088
  ds_read_b64_tr_b16 v[22:23], v99 offset:35088
  v_exp_f32 v50, v50
  v_exp_f32 v51, v51
  v_exp_f32 v52, v52
  v_exp_f32 v53, v53
  s_waitcnt lgkmcnt(4)
  v_mfma_f32_32x32x16_bf16 v[32:47], v[12:15], v[8:11], v[64:79]
  ds_read_b128 v[12:15], v5 offset:39216
  buffer_load_dwordx4 v[216:219], v3, s[32:35], s98 offen offset:3072
  v_exp_f32 v54, v54
  v_exp_f32 v55, v55
  v_exp_f32 v56, v56
  v_exp_f32 v57, v57
  s_waitcnt lgkmcnt(3)
  v_smfmac_f32_32x32x32_bf16 v[80:95], v[16:19], v[48:55], v28
  ds_read_b64_tr_b16 v[16:17], v96 offset:37152
  ds_read_b64_tr_b16 v[18:19], v97 offset:37152
  v_exp_f32 v58, v58
  v_exp_f32 v59, v59
  v_exp_f32 v60, v60
  v_exp_f32 v61, v61
  v_mfma_f32_32x32x16_bf16 v[160:175], v[120:123], v[112:115], v[160:175]
  s_add_u32 s16, s16, 4096
  buffer_load_dwordx4 v[120:123], v3, s[32:35], s16 offen offset:0
  s_add_u32 s15, s15, 4096
  buffer_load_dwordx4 v[112:115], v3, s[32:35], s15 offen offset:0
  v_exp_f32 v62, v62
  v_exp_f32 v63, v63
  v_exp_f32 v32, v32
  v_exp_f32 v33, v33
  s_waitcnt lgkmcnt(3)
  v_smfmac_f32_32x32x32_bf16 v[80:95], v[20:23], v[56:63], v28
  ds_read_b64_tr_b16 v[20:21], v98 offset:37152
  ds_read_b64_tr_b16 v[22:23], v99 offset:37152
  v_exp_f32 v34, v34
  v_exp_f32 v35, v35
  v_exp_f32 v36, v36
  v_exp_f32 v37, v37
  s_waitcnt lgkmcnt(4)
  v_mfma_f32_32x32x16_bf16 v[48:63], v[12:15], v[8:11], v[64:79]
  ds_read_b128 v[12:15], v5 offset:41280
  v_exp_f32 v38, v38
  v_exp_f32 v39, v39
  s_waitcnt vmcnt(11)
  v_mfma_f32_32x32x16_bf16 v[176:191], v[128:131], v[124:127], v[176:191]
  buffer_load_dwordx4 v[128:131], v3, s[32:35], s14 offen offset:1024
  v_exp_f32 v40, v40
  v_exp_f32 v41, v41
  s_waitcnt lgkmcnt(3)
  v_smfmac_f32_32x32x32_bf16 v[80:95], v[16:19], v[32:39], v28
  ds_read_b64_tr_b16 v[16:17], v96 offset:39216
  ds_read_b64_tr_b16 v[18:19], v97 offset:39216
  v_exp_f32 v42, v42
  v_exp_f32 v43, v43
  v_exp_f32 v44, v44
  v_exp_f32 v45, v45
  v_mfma_f32_32x32x16_bf16 v[160:175], v[132:135], v[124:127], v[160:175]
  buffer_load_dwordx4 v[132:135], v3, s[32:35], s16 offen offset:1024
  buffer_load_dwordx4 v[124:127], v3, s[32:35], s15 offen offset:1024
  v_exp_f32 v46, v46
  v_exp_f32 v47, v47
  v_exp_f32 v48, v48
  v_exp_f32 v49, v49
  s_waitcnt lgkmcnt(3)
  v_smfmac_f32_32x32x32_bf16 v[80:95], v[20:23], v[40:47], v28
  ds_read_b64_tr_b16 v[20:21], v98 offset:39216
  ds_read_b64_tr_b16 v[22:23], v99 offset:39216
  v_exp_f32 v50, v50
  v_exp_f32 v51, v51
  v_exp_f32 v52, v52
  v_exp_f32 v53, v53
  s_waitcnt lgkmcnt(4)
  v_mfma_f32_32x32x16_bf16 v[32:47], v[12:15], v[8:11], v[64:79]
  ds_read_b128 v[12:15], v5 offset:43344
  buffer_load_dwordx4 v[220:223], v3, s[32:35], s99 offen offset:3072
  v_exp_f32 v54, v54
  v_exp_f32 v55, v55
  v_exp_f32 v56, v56
  v_exp_f32 v57, v57
  s_waitcnt lgkmcnt(3)
  v_smfmac_f32_32x32x32_bf16 v[80:95], v[16:19], v[48:55], v28
  ds_read_b64_tr_b16 v[16:17], v96 offset:41280
  ds_read_b64_tr_b16 v[18:19], v97 offset:41280
  v_exp_f32 v58, v58
  v_exp_f32 v59, v59
  v_exp_f32 v60, v60
  v_exp_f32 v61, v61
  s_waitcnt vmcnt(12)
  v_mfma_f32_32x32x16_bf16 v[176:191], v[140:143], v[136:139], v[176:191]
  buffer_load_dwordx4 v[140:143], v3, s[32:35], s14 offen offset:2048
  v_exp_f32 v62, v62
  v_exp_f32 v63, v63
  v_exp_f32 v32, v32
  v_exp_f32 v33, v33
  s_waitcnt lgkmcnt(3)
  v_smfmac_f32_32x32x32_bf16 v[80:95], v[20:23], v[56:63], v28
  ds_read_b64_tr_b16 v[20:21], v98 offset:41280
  ds_read_b64_tr_b16 v[22:23], v99 offset:41280
  v_exp_f32 v34, v34
  v_exp_f32 v35, v35
  v_exp_f32 v36, v36
  v_exp_f32 v37, v37
  s_waitcnt lgkmcnt(4)
  v_mfma_f32_32x32x16_bf16 v[48:63], v[12:15], v[8:11], v[64:79]
  ds_read_b128 v[12:15], v5 offset:45408
  v_exp_f32 v38, v38
  v_exp_f32 v39, v39
  v_exp_f32 v40, v40
  v_exp_f32 v41, v41
  s_waitcnt lgkmcnt(3)
  v_smfmac_f32_32x32x32_bf16 v[80:95], v[16:19], v[32:39], v28
  ds_read_b64_tr_b16 v[16:17], v96 offset:43344
  ds_read_b64_tr_b16 v[18:19], v97 offset:43344
  v_exp_f32 v42, v42
  v_exp_f32 v43, v43
  v_exp_f32 v44, v44
  v_exp_f32 v45, v45
  v_mfma_f32_32x32x16_bf16 v[160:175], v[144:147], v[136:139], v[160:175]
  buffer_load_dwordx4 v[144:147], v3, s[32:35], s16 offen offset:2048
  buffer_load_dwordx4 v[136:139], v3, s[32:35], s15 offen offset:2048
  v_exp_f32 v46, v46
  v_exp_f32 v47, v47
  s_cmp_eq_u64 s[96:97], 0
  s_cbranch_scc1 F_pr12
  s_setprio 0
F_pr12:
  v_exp_f32 v48, v48
  v_exp_f32 v49, v49
  s_waitcnt lgkmcnt(3)
  v_smfmac_f32_32x32x32_bf16 v[80:95], v[20:23], v[40:47], v28
  ds_read_b64_tr_b16 v[20:21], v98 offset:43344
  ds_read_b64_tr_b16 v[22:23], v99 offset:43344
  v_exp_f32 v50, v50
  v_exp_f32 v51, v51
  v_exp_f32 v52, v52
  v_exp_f32 v53, v53
  s_waitcnt lgkmcnt(4)
  v_mfma_f32_32x32x16_bf16 v[32:47], v[12:15], v[8:11], v[64:79]
  ds_read_b128 v[12:15], v5 offset:47472
  buffer_load_dwordx4 v[224:227], v4, s[32:35], s98 offen offset:0
  v_exp_f32 v54, v54
  v_exp_f32 v55, v55
  s_waitcnt vmcnt(12)
  v_mfma_f32_32x32x16_bf16 v[176:191], v[152:155], v[148:151], v[176:191]
  buffer_load_dwordx4 v[152:155], v3, s[32:35], s14 offen offset:3072
  v_exp_f32 v56, v56
  v_exp_f32 v57, v57
  s_waitcnt lgkmcnt(3)
  v_smfmac_f32_32x32x32_bf16 v[80:95], v[16:19], v[48:55], v28
  ds_read_b64_tr_b16 v[16:17], v96 offset:45408
  ds_read_b64_tr_b16 v[18:19], v97 offset:45408
  v_exp_f32 v58, v58
  v_exp_f32 v59, v59
  v_exp_f32 v60, v60
  v_exp_f32 v61, v61
  v_mfma_f32_32x32x16_bf16 v[160:175], v[156:159], v[148:151], v[160:175]
  buffer_load_dwordx4 v[156:159], v3, s[32:35], s16 offen offset:3072
  buffer_load_dwordx4 v[148:151], v3, s[32:35], s15 offen offset:3072
  v_exp_f32 v62, v62
  v_exp_f32 v63, v63
  v_exp_f32 v32, v32
  v_exp_f32 v33, v33
  s_waitcnt lgkmcnt(3)
  v_smfmac_f32_32x32x32_bf16 v[80:95], v[20:23], v[56:63], v28
  ds_read_b64_tr_b16 v[20:21], v98 offset:45408
  ds_read_b64_tr_b16 v[22:23], v99 offset:45408
  v_exp_f32 v34, v34
  v_exp_f32 v35, v35
  v_exp_f32 v36, v36
  v_exp_f32 v37, v37
  s_waitcnt lgkmcnt(4)
  v_mfma_f32_32x32x16_bf16 v[48:63], v[12:15], v[8:11], v[64:79]
  ds_read_b128 v[12:15], v5 offset:49536
  v_exp_f32 v38, v38
  v_exp_f32 v39, v39
  v_exp_f32 v40, v40
  v_exp_f32 v41, v41
  s_waitcnt lgkmcnt(3)
  v_smfmac_f32_32x32x32_bf16 v[80:95], v[16:19], v[32:39], v28
  ds_read_b64_tr_b16 v[16:17], v96 offset:47472
  ds_read_b64_tr_b16 v[18:19], v97 offset:47472
  v_exp_f32 v42, v42
  v_exp_f32 v43, v43
  v_exp_f32 v44, v44
  v_exp_f32 v45, v45
  s_waitcnt vmcnt(11)
  v_mfma_f32_32x32x16_bf16 v[176:191], v[116:119], v[112:115], v[176:191]
  s_add_u32 s14, s14, 4096
  buffer_load_dwordx4 v[116:119], v3, s[32:35], s14 offen offset:0
  v_exp_f32 v46, v46
  v_exp_f32 v47, v47
  v_exp_f32 v48, v48
  v_exp_f32 v49, v49
  s_waitcnt lgkmcnt(3)
  v_smfmac_f32_32x32x32_bf16 v[80:95], v[20:23], v[40:47], v28
  ds_read_b64_tr_b16 v[20:21], v98 offset:47472
  ds_read_b64_tr_b16 v[22:23], v99 offset:47472
  v_exp_f32 v50, v50
  v_exp_f32 v51, v51
  v_exp_f32 v52, v52
  v_exp_f32 v53, v53
  s_waitcnt lgkmcnt(4)
  v_mfma_f32_32x32x16_bf16 v[32:47], v[12:15], v[8:11], v[64:79]
  ds_read_b128 v[12:15], v5 offset:51600
  buffer_load_dwordx4 v[228:231], v4, s[32:35], s99 offen offset:0
  v_exp_f32 v54, v54
  v_exp_f32 v55, v55
  v_exp_f32 v56, v56
  v_exp_f32 v57, v57
  s_waitcnt lgkmcnt(3)
  v_smfmac_f32_32x32x32_bf16 v[80:95], v[16:19], v[48:55], v28
  ds_read_b64_tr_b16 v[16:17], v96 offset:49536
  ds_read_b64_tr_b16 v[18:19], v97 offset:49536
  v_exp_f32 v58, v58
  v_exp_f32 v59, v59
  v_exp_f32 v60, v60
  v_exp_f32 v61, v61
  v_mfma_f32_32x32x16_bf16 v[160:175], v[120:123], v[112:115], v[160:175]
  s_add_u32 s16, s16, 4096
  buffer_load_dwordx4 v[120:123], v3, s[32:35], s16 offen offset:0
  s_add_u32 s15, s15, 4096
  buffer_load_dwordx4 v[112:115], v3, s[32:35], s15 offen offset:0
  v_exp_f32 v62, v62
  v_exp_f32 v63, v63
  v_add_u32 v5, 49536, v5
  v_add_u32 v96, 49536, v96
  v_add_u32 v97, 49536, v97
  v_add_u32 v98, 49536, v98
  v_add_u32 v99, 49536, v99
  s_cmp_eq_u64 s[96:97], 0
  s_cbranch_scc1 F_pr13
  s_setprio 1
F_pr13:
  v_exp_f32 v32, v32
  v_exp_f32 v33, v33
  s_waitcnt lgkmcnt(3)
  v_smfmac_f32_32x32x32_bf16 v[80:95], v[20:23], v[56:63], v28
  ds_read_b64_tr_b16 v[20:21], v98 offset:0
  ds_read_b64_tr_b16 v[22:23], v99 offset:0
  v_exp_f32 v34, v34
  v_exp_f32 v35, v35
  v_exp_f32 v36, v36
  v_exp_f32 v37, v37
  s_waitcnt lgkmcnt(4)
  v_mfma_f32_32x32x16_bf16 v[48:63], v[12:15], v[8:11], v[64:79]
  ds_read_b128 v[12:15], v5 offset:4128
  v_exp_f32 v38, v38
  v_exp_f32 v39, v39
  s_waitcnt vmcnt(12)
  v_mfma_f32_32x32x16_bf16 v[176:191], v[128:131], v[124:127], v[176:191]
  buffer_load_dwordx4 v[128:131], v3, s[32:35], s14 offen offset:1024
  v_exp_f32 v40, v40
  v_exp_f32 v41, v41
  s_waitcnt lgkmcnt(3)
  v_smfmac_f32_32x32x32_bf16 v[80:95], v[16:19], v[32:39], v28
  ds_read_b64_tr_b16 v[16:17], v96 offset:2064
  ds_read_b64_tr_b16 v[18:19], v97 offset:2064
  v_exp_f32 v42, v42
  v_exp_f32 v43, v43
  v_exp_f32 v44, v44
  v_exp_f32 v45, v45
  v_mfma_f32_32x32x16_bf16 v[160:175], v[132:135], v[124:127], v[160:175]
  buffer_load_dwordx4 v[132:135], v3, s[32:35], s16 offen offset:1024
  buffer_load_dwordx4 v[124:127], v3, s[32:35], s15 offen offset:1024
  v_exp_f32 v46, v46
  v_exp_f32 v47, v47
  v_exp_f32 v48, v48
  v_exp_f32 v49, v49
  s_waitcnt lgkmcnt(3)
  v_smfmac_f32_32x32x32_bf16 v[80:95], v[20:23], v[40:47], v28
  ds_read_b64_tr_b16 v[20:21], v98 offset:2064
  ds_read_b64_tr_b16 v[22:23], v99 offset:2064
  v_exp_f32 v50, v50
  v_exp_f32 v51, v51
  v_exp_f32 v52, v52
  v_exp_f32 v53, v53
  s_waitcnt lgkmcnt(4)
  v_mfma_f32_32x32x16_bf16 v[32:47], v[12:15], v[8:11], v[64:79]
  ds_read_b128 v[12:15], v5 offset:6192
  buffer_load_dwordx4 v[232:235], v4, s[32:35], s98 offen offset:1024
  v_exp_f32 v54, v54
  v_exp_f32 v55, v55
  v_exp_f32 v56, v56
  v_exp_f32 v57, v57
  s_waitcnt lgkmcnt(3)
  v_smfmac_f32_32x32x32_bf16 v[80:95], v[16:19], v[48:55], v28
  ds_read_b64_tr_b16 v[16:17], v96 offset:4128
  ds_read_b64_tr_b16 v[18:19], v97 offset:4128
  v_exp_f32 v58, v58
  v_exp_f32 v59, v59
  v_exp_f32 v60, v60
  v_exp_f32 v61, v61
  s_waitcnt vmcnt(12)
  v_mfma_f32_32x32x16_bf16 v[176:191], v[140:143], v[136:139], v[176:191]
  buffer_load_dwordx4 v[140:143], v3, s[32:35], s14 offen offset:2048
  v_exp_f32 v62, v62
  v_exp_f32 v63, v63
  v_exp_f32 v32, v32
  v_exp_f32 v33, v33
  s_waitcnt lgkmcnt(3)
  v_smfmac_f32_32x32x32_bf16 v[80:95], v[20:23], v[56:63], v28
  ds_read_b64_tr_b16 v[20:21], v98 offset:4128
  ds_read_b64_tr_b16 v[22:23], v99 offset:4128
  v_exp_f32 v34, v34
  v_exp_f32 v35, v35
  v_exp_f32 v36, v36
  v_exp_f32 v37, v37
  s_waitcnt lgkmcnt(4)
  v_mfma_f32_32x32x16_bf16 v[48:63], v[12:15], v[8:11], v[64:79]
  ds_read_b128 v[12:15], v5 offset:8256
  v_exp_f32 v38, v38
  v_exp_f32 v39, v39
  v_exp_f32 v40, v40
  v_exp_f32 v41, v41
  s_waitcnt lgkmcnt(3)
  v_smfmac_f32_32x32x32_bf16 v[80:95], v[16:19], v[32:39], v28
  ds_read_b64_tr_b16 v[16:17], v96 offset:6192
  ds_read_b64_tr_b16 v[18:19], v97 offset:6192
  v_exp_f32 v42, v42
  v_exp_f32 v43, v43
  v_exp_f32 v44, v44
  v_exp_f32 v45, v45
  v_mfma_f32_32x32x16_bf16 v[160:175], v[144:147], v[136:139], v[160:175]
  buffer_load_dwordx4 v[144:147], v3, s[32:35], s16 offen offset:2048
  buffer_load_dwordx4 v[136:139], v3, s[32:35], s15 offen offset:2048
  v_exp_f32 v46, v46
  v_exp_f32 v47, v47
  v_exp_f32 v48, v48
  v_exp_f32 v49, v49
  s_waitcnt lgkmcnt(3)
  v_smfmac_f32_32x32x32_bf16 v[80:95], v[20:23], v[40:47], v28
  ds_read_b64_tr_b16 v[20:21], v98 offset:6192
  ds_read_b64_tr_b16 v[22:23], v99 offset:6192
  v_exp_f32 v50, v50
  v_exp_f32 v51, v51
  v_exp_f32 v52, v52
  v_exp_f32 v53, v53
  s_waitcnt lgkmcnt(4)
  v_mfma_f32_32x32x16_bf16 v[32:47], v[12:15], v[8:11], v[64:79]
  ds_read_b128 v[12:15], v5 offset:10320
  buffer_load_dwordx4 v[236:239], v4, s[32:35], s99 offen offset:1024
  v_exp_f32 v54, v54
  v_exp_f32 v55, v55
  s_waitcnt vmcnt(12)
  v_mfma_f32_32x32x16_bf16 v[176:191], v[152:155], v[148:151], v[176:191]
  buffer_load_dwordx4 v[152:155], v3, s[32:35], s14 offen offset:3072
  v_exp_f32 v56, v56
  v_exp_f32 v57, v57
  s_waitcnt lgkmcnt(3)
  v_smfmac_f32_32x32x32_bf16 v[80:95], v[16:19], v[48:55], v28
  ds_read_b64_tr_b16 v[16:17], v96 offset:8256
  ds_read_b64_tr_b16 v[18:19], v97 offset:8256
  v_exp_f32 v58, v58
  v_exp_f32 v59, v59
  v_exp_f32 v60, v60
  v_exp_f32 v61, v61
  v_mfma_f32_32x32x16_bf16 v[160:175], v[156:159], v[148:151], v[160:175]
  buffer_load_dwordx4 v[156:159], v3, s[32:35], s16 offen offset:3072
  buffer_load_dwordx4 v[148:151], v3, s[32:35], s15 offen offset:3072
  v_exp_f32 v62, v62
  v_exp_f32 v63, v63
  v_exp_f32 v32, v32
  v_exp_f32 v33, v33
  s_waitcnt lgkmcnt(3)
  v_smfmac_f32_32x32x32_bf16 v[80:95], v[20:23], v[56:63], v28
  ds_read_b64_tr_b16 v[20:21], v98 offset:8256
  ds_read_b64_tr_b16 v[22:23], v99 offset:8256
  v_exp_f32 v34, v34
  v_exp_f32 v35, v35
  v_exp_f32 v36, v36
  v_exp_f32 v37, v37
  s_waitcnt lgkmcnt(4)
  v_mfma_f32_32x32x16_bf16 v[48:63], v[12:15], v[8:11], v[64:79]
  ds_read_b128 v[12:15], v5 offset:12384
  v_exp_f32 v38, v38
  v_exp_f32 v39, v39
  v_exp_f32 v40, v40
  v_exp_f32 v41, v41
  s_waitcnt lgkmcnt(3)
  v_smfmac_f32_32x32x32_bf16 v[80:95], v[16:19], v[32:39], v28
  ds_read_b64_tr_b16 v[16:17], v96 offset:10320
  ds_read_b64_tr_b16 v[18:19], v97 offset:10320
  v_exp_f32 v42, v42
  v_exp_f32 v43, v43
  v_exp_f32 v44, v44
  v_exp_f32 v45, v45
  s_waitcnt vmcnt(11)
  v_mfma_f32_32x32x16_bf16 v[176:191], v[116:119], v[112:115], v[176:191]
  s_add_u32 s14, s14, 4096
  buffer_load_dwordx4 v[116:119], v3, s[32:35], s14 offen offset:0
  v_exp_f32 v46, v46
  v_exp_f32 v47, v47
  s_cmp_eq_u64 s[96:97], 0
  s_cbranch_scc1 F_pr14
  s_setprio 0
F_pr14:
  v_exp_f32 v48, v48
  v_exp_f32 v49, v49
  s_waitcnt lgkmcnt(3)
  v_smfmac_f32_32x32x32_bf16 v[80:95], v[20:23], v[40:47], v28
  ds_read_b64_tr_b16 v[20:21], v98 offset:10320
  ds_read_b64_tr_b16 v[22:23], v99 offset:10320
  v_exp_f32 v50, v50
  v_exp_f32 v51, v51
  v_exp_f32 v52, v52
  v_exp_f32 v53, v53
  s_waitcnt lgkmcnt(4)
  v_mfma_f32_32x32x16_bf16 v[32:47], v[12:15], v[8:11], v[64:79]
  ds_read_b128 v[12:15], v5 offset:14448
  buffer_load_dwordx4 v[240:243], v4, s[32:35], s98 offen offset:2048
  v_exp_f32 v54, v54
  v_exp_f32 v55, v55
  v_exp_f32 v56, v56
  v_exp_f32 v57, v57
  s_waitcnt lgkmcnt(3)
  v_smfmac_f32_32x32x32_bf16 v[80:95], v[16:19], v[48:55], v28
  ds_read_b64_tr_b16 v[16:17], v96 offset:12384
  ds_read_b64_tr_b16 v[18:19], v97 offset:12384
  v_exp_f32 v58, v58
  v_exp_f32 v59, v59
  v_exp_f32 v60, v60
  v_exp_f32 v61, v61
  v_mfma_f32_32x32x16_bf16 v[160:175], v[120:123], v[112:115], v[160:175]
  s_add_u32 s16, s16, 4096
  buffer_load_dwordx4 v[120:123], v3, s[32:35], s16 offen offset:0
  s_add_u32 s15, s15, 4096
  buffer_load_dwordx4 v[112:115], v3, s[32:35], s15 offen offset:0
  v_exp_f32 v62, v62
  v_exp_f32 v63, v63
  v_exp_f32 v32, v32
  v_exp_f32 v33, v33
  s_waitcnt lgkmcnt(3)
  v_smfmac_f32_32x32x32_bf16 v[80:95], v[20:23], v[56:63], v28
  ds_read_b64_tr_b16 v[20:21], v98 offset:12384
  ds_read_b64_tr_b16 v[22:23], v99 offset:12384
  v_exp_f32 v34, v34
  v_exp_f32 v35, v35
  v_exp_f32 v36, v36
  v_exp_f32 v37, v37
  s_waitcnt lgkmcnt(4)
  v_mfma_f32_32x32x16_bf16 v[48:63], v[12:15], v[8:11], v[64:79]
  ds_read_b128 v[12:15], v5 offset:16512
  v_exp_f32 v38, v38
  v_exp_f32 v39, v39
  s_waitcnt vmcnt(12)
  v_mfma_f32_32x32x16_bf16 v[176:191], v[128:131], v[124:127], v[176:191]
  buffer_load_dwordx4 v[128:131], v3, s[32:35], s14 offen offset:1024
  v_exp_f32 v40, v40
  v_exp_f32 v41, v41
  s_waitcnt lgkmcnt(3)
  v_smfmac_f32_32x32x32_bf16 v[80:95], v[16:19], v[32:39], v28
  ds_read_b64_tr_b16 v[16:17], v96 offset:14448
  ds_read_b64_tr_b16 v[18:19], v97 offset:14448
  v_exp_f32 v42, v42
  v_exp_f32 v43, v43
  v_exp_f32 v44, v44
  v_exp_f32 v45, v45
  v_mfma_f32_32x32x16_bf16 v[160:175], v[132:135], v[124:127], v[160:175]
  buffer_load_dwordx4 v[132:135], v3, s[32:35], s16 offen offset:1024
  buffer_load_dwordx4 v[124:127], v3, s[32:35], s15 offen offset:1024
  v_exp_f32 v46, v46
  v_exp_f32 v47, v47
  v_exp_f32 v48, v48
  v_exp_f32 v49, v49
  s_waitcnt lgkmcnt(3)
  v_smfmac_f32_32x32x32_bf16 v[80:95], v[20:23], v[40:47], v28
  ds_read_b64_tr_b16 v[20:21], v98 offset:14448
  ds_read_b64_tr_b16 v[22:23], v99 offset:14448
  v_exp_f32 v50, v50
  v_exp_f32 v51, v51
  v_exp_f32 v52, v52
  v_exp_f32 v53, v53
  s_waitcnt lgkmcnt(4)
  v_mfma_f32_32x32x16_bf16 v[32:47], v[12:15], v[8:11], v[64:79]
  ds_read_b128 v[12:15], v5 offset:18576
  buffer_load_dwordx4 v[244:247], v4, s[32:35], s99 offen offset:2048
  v_exp_f32 v54, v54
  v_exp_f32 v55, v55
  v_exp_f32 v56, v56
  v_exp_f32 v57, v57
  s_waitcnt lgkmcnt(3)
  v_smfmac_f32_32x32x32_bf16 v[80:95], v[16:19], v[48:55], v28
  ds_read_b64_tr_b16 v[16:17], v96 offset:16512
  ds_read_b64_tr_b16 v[18:19], v97 offset:16512
  v_exp_f32 v58, v58
  v_exp_f32 v59, v59
  v_exp_f32 v60, v60
  v_exp_f32 v61, v61
  s_waitcnt vmcnt(12)
  v_mfma_f32_32x32x16_bf16 v[176:191], v[140:143], v[136:139], v[176:191]
  buffer_load_dwordx4 v[140:143], v3, s[32:35], s14 offen offset:2048
  v_exp_f32 v62, v62
  v_exp_f32 v63, v63
  s_cmp_eq_u64 s[96:97], 0
  s_cbranch_scc1 F_pr15
  s_setprio 1
F_pr15:
  v_exp_f32 v32, v32
  v_exp_f32 v33, v33
  s_waitcnt lgkmcnt(3)
  v_smfmac_f32_32x32x32_bf16 v[80:95], v[20:23], v[56:63], v28
  ds_read_b64_tr_b16 v[20:21], v98 offset:16512
  ds_read_b64_tr_b16 v[22:23], v99 offset:16512
  v_exp_f32 v34, v34
  v_exp_f32 v35, v35
  v_exp_f32 v36, v36
  v_exp_f32 v37, v37
  s_waitcnt lgkmcnt(4)
  v_mfma_f32_32x32x16_bf16 v[48:63], v[12:15], v[8:11], v[64:79]
  ds_read_b128 v[12:15], v5 offset:20640
  v_exp_f32 v38, v38
  v_exp_f32 v39, v39
  v_mfma_f32_32x32x16_bf16 v[160:175], v[144:147], v[136:139], v[160:175]
  buffer_load_dwordx4 v[144:147], v3, s[32:35], s16 offen offset:2048
  buffer_load_dwordx4 v[136:139], v3, s[32:35], s15 offen offset:2048
  v_exp_f32 v40, v40
  v_exp_f32 v41, v41
  s_waitcnt lgkmcnt(3)
  v_smfmac_f32_32x32x32_bf16 v[80:95], v[16:19], v[32:39], v28
  ds_read_b64_tr_b16 v[16:17], v96 offset:18576
  ds_read_b64_tr_b16 v[18:19], v97 offset:18576
  v_exp_f32 v42, v42
  v_exp_f32 v43, v43
  v_exp_f32 v44, v44
  v_exp_f32 v45, v45
  s_waitcnt vmcnt(11)
  v_mfma_f32_32x32x16_bf16 v[176:191], v[152:155], v[148:151], v[176:191]
  buffer_load_dwordx4 v[152:155], v3, s[32:35], s14 offen offset:3072
  v_exp_f32 v46, v46
  v_exp_f32 v47, v47
  v_exp_f32 v48, v48
  v_exp_f32 v49, v49
  s_waitcnt lgkmcnt(3)
  v_smfmac_f32_32x32x32_bf16 v[80:95], v[20:23], v[40:47], v28
  ds_read_b64_tr_b16 v[20:21], v98 offset:18576
  ds_read_b64_tr_b16 v[22:23], v99 offset:18576
  v_exp_f32 v50, v50
  v_exp_f32 v51, v51
  v_exp_f32 v52, v52
  v_exp_f32 v53, v53
  s_waitcnt lgkmcnt(4)
  v_mfma_f32_32x32x16_bf16 v[32:47], v[12:15], v[8:11], v[64:79]
  ds_read_b128 v[12:15], v5 offset:22704
  buffer_load_dwordx4 v[248:251], v4, s[32:35], s98 offen offset:3072
  v_exp_f32 v54, v54
  v_exp_f32 v55, v55
  v_exp_f32 v56, v56
  v_exp_f32 v57, v57
  s_waitcnt lgkmcnt(3)
  v_smfmac_f32_32x32x32_bf16 v[80:95], v[16:19], v[48:55], v28
  ds_read_b64_tr_b16 v[16:17], v96 offset:20640
  ds_read_b64_tr_b16 v[18:19], v97 offset:20640
  v_exp_f32 v58, v58
  v_exp_f32 v59, v59
  v_exp_f32 v60, v60
  v_exp_f32 v61, v61
  v_mfma_f32_32x32x16_bf16 v[160:175], v[156:159], v[148:151], v[160:175]
  buffer_load_dwordx4 v[156:159], v3, s[32:35], s16 offen offset:3072
  buffer_load_dwordx4 v[148:151], v3, s[32:35], s15 offen offset:3072
  v_exp_f32 v62, v62
  v_exp_f32 v63, v63
  v_exp_f32 v32, v32
  v_exp_f32 v33, v33
  s_waitcnt lgkmcnt(3)
  v_smfmac_f32_32x32x32_bf16 v[80:95], v[20:23], v[56:63], v28
  ds_read_b64_tr_b16 v[20:21], v98 offset:20640
  ds_read_b64_tr_b16 v[22:23], v99 offset:20640
  v_exp_f32 v34, v34
  v_exp_f32 v35, v35
  v_exp_f32 v36, v36
  v_exp_f32 v37, v37
  s_waitcnt lgkmcnt(4)
  v_mfma_f32_32x32x16_bf16 v[48:63], v[12:15], v[8:11], v[64:79]
  ds_read_b128 v[12:15], v5 offset:24768
  v_exp_f32 v38, v38
  v_exp_f32 v39, v39
  v_exp_f32 v40, v40
  v_exp_f32 v41, v41
  s_waitcnt lgkmcnt(3)
  v_smfmac_f32_32x32x32_bf16 v[80:95], v[16:19], v[32:39], v28
  ds_read_b64_tr_b16 v[16:17], v96 offset:22704
  ds_read_b64_tr_b16 v[18:19], v97 offset:22704
  v_exp_f32 v42, v42
  v_exp_f32 v43, v43
  v_exp_f32 v44, v44
  v_exp_f32 v45, v45
  s_waitcnt vmcnt(11)
  v_mfma_f32_32x32x16_bf16 v[176:191], v[116:119], v[112:115], v[176:191]
  s_add_u32 s14, s14, 4096
  buffer_load_dwordx4 v[116:119], v3, s[32:35], s14 offen offset:0
  v_exp_f32 v46, v46
  v_exp_f32 v47, v47
  v_exp_f32 v48, v48
  v_exp_f32 v49, v49
  s_waitcnt lgkmcnt(3)
  v_smfmac_f32_32x32x32_bf16 v[80:95], v[20:23], v[40:47], v28
  ds_read_b64_tr_b16 v[20:21], v98 offset:22704
  ds_read_b64_tr_b16 v[22:23], v99 offset:22704
  v_exp_f32 v50, v50
  v_exp_f32 v51, v51
  v_exp_f32 v52, v52
  v_exp_f32 v53, v53
  s_waitcnt lgkmcnt(4)
  v_mfma_f32_32x32x16_bf16 v[32:47], v[12:15], v[8:11], v[64:79]
  ds_read_b128 v[12:15], v5 offset:26832
  buffer_load_dwordx4 v[252:255], v4, s[32:35], s99 offen offset:3072
  v_exp_f32 v54, v54
  v_exp_f32 v55, v55
  v_mfma_f32_32x32x16_bf16 v[160:175], v[120:123], v[112:115], v[160:175]
  s_add_u32 s16, s16, 4096
  buffer_load_dwordx4 v[120:123], v3, s[32:35], s16 offen offset:0
  s_add_u32 s15, s15, 4096
  buffer_load_dwordx4 v[112:115], v3, s[32:35], s15 offen offset:0
  v_exp_f32 v56, v56
  v_exp_f32 v57, v57
  s_waitcnt lgkmcnt(3)
  v_smfmac_f32_32x32x32_bf16 v[80:95], v[16:19], v[48:55], v28
  ds_read_b64_tr_b16 v[16:17], v96 offset:24768
  ds_read_b64_tr_b16 v[18:19], v97 offset:24768
  v_exp_f32 v58, v58
  v_exp_f32 v59, v59
  v_exp_f32 v60, v60
  v_exp_f32 v61, v61
  s_waitcnt vmcnt(12)
  v_mfma_f32_32x32x16_bf16 v[176:191], v[128:131], v[124:127], v[176:191]
  buffer_load_dwordx4 v[128:131], v3, s[32:35], s14 offen offset:1024
  v_exp_f32 v62, v62
  v_exp_f32 v63, v63
  v_exp_f32 v32, v32
  v_exp_f32 v33, v33
  s_waitcnt lgkmcnt(3)
  v_smfmac_f32_32x32x32_bf16 v[80:95], v[20:23], v[56:63], v28
  ds_read_b64_tr_b16 v[20:21], v98 offset:24768
  ds_read_b64_tr_b16 v[22:23], v99 offset:24768
  v_exp_f32 v34, v34
  v_exp_f32 v35, v35
  v_exp_f32 v36, v36
  v_exp_f32 v37, v37
  s_waitcnt lgkmcnt(4)
  v_mfma_f32_32x32x16_bf16 v[48:63], v[12:15], v[8:11], v[64:79]
  ds_read_b128 v[12:15], v5 offset:28896
  v_exp_f32 v38, v38
  v_exp_f32 v39, v39
  v_exp_f32 v40, v40
  v_exp_f32 v41, v41
  s_waitcnt lgkmcnt(3)
  v_smfmac_f32_32x32x32_bf16 v[80:95], v[16:19], v[32:39], v28
  ds_read_b64_tr_b16 v[16:17], v96 offset:26832
  ds_read_b64_tr_b16 v[18:19], v97 offset:26832
  v_exp_f32 v42, v42
  v_exp_f32 v43, v43
  v_exp_f32 v44, v44
  v_exp_f32 v45, v45
  v_mfma_f32_32x32x16_bf16 v[160:175], v[132:135], v[124:127], v[160:175]
  buffer_load_dwordx4 v[132:135], v3, s[32:35], s16 offen offset:1024
  buffer_load_dwordx4 v[124:127], v3, s[32:35], s15 offen offset:1024
  v_exp_f32 v46, v46
  v_exp_f32 v47, v47
  s_cmp_eq_u64 s[96:97], 0
  s_cbranch_scc1 F_pr16
  s_setprio 0
F_pr16:
  v_exp_f32 v48, v48
  v_exp_f32 v49, v49
  s_waitcnt lgkmcnt(3)
  v_smfmac_f32_32x32x32_bf16 v[80:95], v[20:23], v[40:47], v28
  ds_read_b64_tr_b16 v[20:21], v98 offset:26832
  ds_read_b64_tr_b16 v[22:23], v99 offset:26832
  v_exp_f32 v50, v50
  v_exp_f32 v51, v51
  v_exp_f32 v52, v52
  v_exp_f32 v53, v53
  s_waitcnt lgkmcnt(4)
  v_mfma_f32_32x32x16_bf16 v[32:47], v[12:15], v[8:11], v[64:79]
  ds_read_b128 v[12:15], v5 offset:30960
  v_exp_f32 v54, v54
  v_exp_f32 v55, v55
  v_exp_f32 v56, v56
  v_exp_f32 v57, v57
  s_waitcnt lgkmcnt(3)
  v_smfmac_f32_32x32x32_bf16 v[80:95], v[16:19], v[48:55], v28
  ds_read_b64_tr_b16 v[16:17], v96 offset:28896
  ds_read_b64_tr_b16 v[18:19], v97 offset:28896
  v_exp_f32 v58, v58
  v_exp_f32 v59, v59
  v_exp_f32 v60, v60
  v_exp_f32 v61, v61
  s_waitcnt vmcnt(11)
  v_mfma_f32_32x32x16_bf16 v[176:191], v[140:143], v[136:139], v[176:191]
  buffer_load_dwordx4 v[140:143], v3, s[32:35], s14 offen offset:2048
  v_exp_f32 v62, v62
  v_exp_f32 v63, v63
  v_exp_f32 v32, v32
  v_exp_f32 v33, v33
  s_waitcnt lgkmcnt(3)
  v_smfmac_f32_32x32x32_bf16 v[80:95], v[20:23], v[56:63], v28
  ds_read_b64_tr_b16 v[20:21], v98 offset:28896
  ds_read_b64_tr_b16 v[22:23], v99 offset:28896
  v_exp_f32 v34, v34
  v_exp_f32 v35, v35
  v_exp_f32 v36, v36
  v_exp_f32 v37, v37
  s_waitcnt lgkmcnt(4)
  v_mfma_f32_32x32x16_bf16 v[48:63], v[12:15], v[8:11], v[64:79]
  v_exp_f32 v38, v38
  v_exp_f32 v39, v39
  v_mfma_f32_32x32x16_bf16 v[160:175], v[144:147], v[136:139], v[160:175]
  buffer_load_dwordx4 v[144:147], v3, s[32:35], s16 offen offset:2048
  buffer_load_dwordx4 v[136:139], v3, s[32:35], s15 offen offset:2048
  v_exp_f32 v40, v40
  v_exp_f32 v41, v41
  s_waitcnt lgkmcnt(2)
  v_smfmac_f32_32x32x32_bf16 v[80:95], v[16:19], v[32:39], v28
  ds_read_b64_tr_b16 v[16:17], v96 offset:30960
  ds_read_b64_tr_b16 v[18:19], v97 offset:30960
  v_exp_f32 v42, v42
  v_exp_f32 v43, v43
  v_exp_f32 v44, v44
  v_exp_f32 v45, v45
  s_waitcnt vmcnt(10)
  v_mfma_f32_32x32x16_bf16 v[176:191], v[152:155], v[148:151], v[176:191]
  buffer_load_dwordx4 v[152:155], v3, s[32:35], s14 offen offset:3072
  v_exp_f32 v46, v46
  v_exp_f32 v47, v47
  v_exp_f32 v48, v48
  v_exp_f32 v49, v49
  s_waitcnt lgkmcnt(2)
  v_smfmac_f32_32x32x32_bf16 v[80:95], v[20:23], v[40:47], v28
  ds_read_b64_tr_b16 v[20:21], v98 offset:30960
  ds_read_b64_tr_b16 v[22:23], v99 offset:30960
  v_exp_f32 v50, v50
  v_exp_f32 v51, v51
  v_exp_f32 v52, v52
  v_exp_f32 v53, v53
  v_exp_f32 v54, v54
  v_exp_f32 v55, v55
  v_exp_f32 v56, v56
  v_exp_f32 v57, v57
  s_waitcnt lgkmcnt(2)
  v_smfmac_f32_32x32x32_bf16 v[80:95], v[16:19], v[48:55], v28
  v_exp_f32 v58, v58
  v_exp_f32 v59, v59
  v_exp_f32 v60, v60
  v_exp_f32 v61, v61
  v_mfma_f32_32x32x16_bf16 v[160:175], v[156:159], v[148:151], v[160:175]
  buffer_load_dwordx4 v[156:159], v3, s[32:35], s16 offen offset:3072
  buffer_load_dwordx4 v[148:151], v3, s[32:35], s15 offen offset:3072
  v_exp_f32 v62, v62
  v_exp_f32 v63, v63
  s_waitcnt lgkmcnt(0)
  s_nop 0
  v_smfmac_f32_32x32x32_bf16 v[80:95], v[20:23], v[56:63], v28
  s_setprio 0
  s_lshl_b32 s70, s54, 3
  s_add_u32 s70, s70, s48
  s_lshl_b32 s70, s70, 5
  s_add_u32 s70, s70, s53
  s_lshl_b32 s71, s70, 3
  s_add_u32 s71, s71, 24281088
  s_lshl_b32 s70, s70, 10
  s_add_u32 s70, s70, 18874368
  v_mov_b32 v103, 0x5f800000
  v_mov_b32 v104, 0x7e800000
  s_waitcnt vmcnt(9)
  v_mfma_f32_32x32x16_bf16 v[176:191], v[116:119], v[112:115], v[176:191]
  s_nop 3
  v_add_f32 v102, |v80|, |v81|
  v_add_f32 v102, v102, |v82|
  v_add_f32 v102, v102, |v83|
  v_add_f32 v102, v102, |v84|
  v_add_f32 v102, v102, |v85|
  v_add_f32 v102, v102, |v86|
  v_add_f32 v102, v102, |v87|
  v_cmp_lt_f32 vcc, v88, v103
  v_cmp_lt_f32 s[72:73], v102, v104
  s_and_b64 s[72:73], s[72:73], vcc
  s_cmp_eq_u64 s[72:73], exec
  s_cbranch_scc0 F_slow
F_fin:
  v_rcp_f32 v102, v88
  s_nop 0
  v_mul_f32 v102, v102, v6
  v_mul_f32 v80, v80, v102
  v_mul_f32 v81, v81, v102
  v_mul_f32 v82, v82, v102
  v_mul_f32 v83, v83, v102
  v_mul_f32 v84, v84, v102
  v_mul_f32 v85, v85, v102
  v_mul_f32 v86, v86, v102
  v_mul_f32 v87, v87, v102
  v_cvt_pk_bf16_f32 v24, v80, v81
  v_cvt_pk_bf16_f32 v25, v82, v83
  v_cvt_pk_bf16_f32 v26, v84, v85
  v_cvt_pk_bf16_f32 v27, v86, v87
  buffer_store_dwordx4 v[24:27], v3, s[32:35], s70 offen sc1
  v_mfma_f32_32x32x16_bf16 v[160:175], v[120:123], v[112:115], v[160:175]
  s_waitcnt vmcnt(7)
  v_mfma_f32_32x32x16_bf16 v[176:191], v[128:131], v[124:127], v[176:191]
  v_mfma_f32_32x32x16_bf16 v[160:175], v[132:135], v[124:127], v[160:175]
  s_waitcnt vmcnt(4)
  v_mfma_f32_32x32x16_bf16 v[176:191], v[140:143], v[136:139], v[176:191]
  v_mfma_f32_32x32x16_bf16 v[160:175], v[144:147], v[136:139], v[160:175]
  s_waitcnt vmcnt(1)
  v_mfma_f32_32x32x16_bf16 v[176:191], v[152:155], v[148:151], v[176:191]
  v_mfma_f32_32x32x16_bf16 v[160:175], v[156:159], v[148:151], v[160:175]
  s_lshl_b32 s72, s3, 3
  s_lshl_b32 s73, s19, 5
  s_add_u32 s73, s73, s72
  s_lshl_b32 s74, s73, 3
  s_add_u32 s74, s74, 24281088
  s_lshl_b32 s73, s73, 10
  s_add_u32 s75, s73, 18874368
  v_sub_f32 v7, 1.0, v7
  s_and_b32 s72, s48, 1
  s_lshl_b32 s72, s72, 15
  s_lshl_b32 s73, s3, 11
  s_add_u32 s77, s72, s73
  s_lshl_b32 s73, s3, 13
  s_add_u32 s78, s72, s73
  v_add_u32 v104, s77, v3
  v_add_u32 v105, s78, v3
  v_and_b32 v106, 31, v2
  v_lshrrev_b32 v107, 5, v2
  v_lshlrev_b32 v107, 4, v107
  v_lshl_add_u32 v106, v106, 10, v107
  s_lshl_b32 s77, s19, 15
  s_lshl_b32 s78, s85, 7
  s_add_u32 s77, s77, s78
  s_lshl_b32 s78, s3, 5
  s_add_u32 s77, s77, s78
  s_mov_b32 s44, s94
  s_and_b32 s45, s95, 0xffff
  s_mov_b32 s46, 2097152
  s_mov_b32 s47, 0x20000
  v_mul_f32 v112, v176, v7
  v_mul_f32 v113, v177, v7
  v_mul_f32 v114, v178, v7
  v_mul_f32 v115, v179, v7
  v_mul_f32 v116, v180, v7
  v_mul_f32 v117, v181, v7
  v_mul_f32 v118, v182, v7
  v_mul_f32 v119, v183, v7
  v_mul_f32 v120, v184, v7
  v_mul_f32 v121, v185, v7
  v_mul_f32 v122, v186, v7
  v_mul_f32 v123, v187, v7
  v_mul_f32 v124, v188, v7
  v_mul_f32 v125, v189, v7
  v_mul_f32 v126, v190, v7
  v_mul_f32 v127, v191, v7
  v_mul_f32 v128, v160, v7
  v_mul_f32 v129, v161, v7
  v_mul_f32 v130, v162, v7
  v_mul_f32 v131, v163, v7
  v_mul_f32 v132, v164, v7
  v_mul_f32 v133, v165, v7
  v_mul_f32 v134, v166, v7
  v_mul_f32 v135, v167, v7
  v_mul_f32 v136, v168, v7
  v_mul_f32 v137, v169, v7
  v_mul_f32 v138, v170, v7
  v_mul_f32 v139, v171, v7
  v_mul_f32 v140, v172, v7
  v_mul_f32 v141, v173, v7
  v_mul_f32 v142, v174, v7
  v_mul_f32 v143, v175, v7
  s_mov_b32 s74, 0
  s_mov_b32 s79, 32768
  s_barrier
  buffer_load_dwordx4 v[32:35], v3, s[32:35], s75 offen offset:0
  buffer_load_dwordx4 v[36:39], v3, s[32:35], s75 offen offset:1024
  buffer_load_dwordx4 v[40:43], v3, s[32:35], s75 offen offset:2048
  buffer_load_dwordx4 v[44:47], v3, s[32:35], s75 offen offset:3072
  buffer_load_dwordx4 v[48:51], v4, s[32:35], s75 offen offset:0
  buffer_load_dwordx4 v[52:55], v4, s[32:35], s75 offen offset:1024
  buffer_load_dwordx4 v[56:59], v4, s[32:35], s75 offen offset:2048
  buffer_load_dwordx4 v[60:63], v4, s[32:35], s75 offen offset:3072
  s_waitcnt vmcnt(4)
  v_max3_u32 v108, v32, v33, v34
  v_max_u32 v108, v108, v35
  v_max3_u32 v108, v108, v36, v37
  v_max3_u32 v108, v108, v38, v39
  v_max3_u32 v108, v108, v40, v41
  v_max3_u32 v108, v108, v42, v43
  v_max3_u32 v108, v108, v44, v45
  v_max3_u32 v108, v108, v46, v47
  v_cmp_eq_u32 vcc, -1, v108
  s_cbranch_vccnz F_ol_i0
  v_mfma_f32_32x32x16_bf16 v[112:127], v[192:195], v[32:35], v[112:127]
  v_mfma_f32_32x32x16_bf16 v[128:143], v[196:199], v[32:35], v[128:143]
  v_mfma_f32_32x32x16_bf16 v[112:127], v[200:203], v[36:39], v[112:127]
  v_mfma_f32_32x32x16_bf16 v[128:143], v[204:207], v[36:39], v[128:143]
  v_mfma_f32_32x32x16_bf16 v[112:127], v[208:211], v[40:43], v[112:127]
  v_mfma_f32_32x32x16_bf16 v[128:143], v[212:215], v[40:43], v[128:143]
  v_mfma_f32_32x32x16_bf16 v[112:127], v[216:219], v[44:47], v[112:127]
  v_mfma_f32_32x32x16_bf16 v[128:143], v[220:223], v[44:47], v[128:143]
  s_bitset1_b32 s74, 0
F_ol_i0:
  s_waitcnt vmcnt(0)
  v_max3_u32 v108, v48, v49, v50
  v_max_u32 v108, v108, v51
  v_max3_u32 v108, v108, v52, v53
  v_max3_u32 v108, v108, v54, v55
  v_max3_u32 v108, v108, v56, v57
  v_max3_u32 v108, v108, v58, v59
  v_max3_u32 v108, v108, v60, v61
  v_max3_u32 v108, v108, v62, v63
  v_cmp_eq_u32 vcc, -1, v108
  s_cbranch_vccnz F_ol_i1
  v_mfma_f32_32x32x16_bf16 v[112:127], v[224:227], v[48:51], v[112:127]
  v_mfma_f32_32x32x16_bf16 v[128:143], v[228:231], v[48:51], v[128:143]
  v_mfma_f32_32x32x16_bf16 v[112:127], v[232:235], v[52:55], v[112:127]
  v_mfma_f32_32x32x16_bf16 v[128:143], v[236:239], v[52:55], v[128:143]
  v_mfma_f32_32x32x16_bf16 v[112:127], v[240:243], v[56:59], v[112:127]
  v_mfma_f32_32x32x16_bf16 v[128:143], v[244:247], v[56:59], v[128:143]
  v_mfma_f32_32x32x16_bf16 v[112:127], v[248:251], v[60:63], v[112:127]
  v_mfma_f32_32x32x16_bf16 v[128:143], v[252:255], v[60:63], v[128:143]
  s_bitset1_b32 s74, 1
F_ol_i1:
  s_cmp_eq_u32 s74, 3
  s_cbranch_scc1 F_ol_done
F_ol_top:
  s_sleep 4
  s_bitcmp1_b32 s74, 0
  s_cbranch_scc1 F_ol_l0
  buffer_load_dwordx4 v[32:35], v3, s[32:35], s75 offen offset:0 sc1
  buffer_load_dwordx4 v[36:39], v3, s[32:35], s75 offen offset:1024 sc1
  buffer_load_dwordx4 v[40:43], v3, s[32:35], s75 offen offset:2048 sc1
  buffer_load_dwordx4 v[44:47], v3, s[32:35], s75 offen offset:3072 sc1
F_ol_l0:
  s_bitcmp1_b32 s74, 1
  s_cbranch_scc1 F_ol_l1
  buffer_load_dwordx4 v[48:51], v4, s[32:35], s75 offen offset:0 sc1
  buffer_load_dwordx4 v[52:55], v4, s[32:35], s75 offen offset:1024 sc1
  buffer_load_dwordx4 v[56:59], v4, s[32:35], s75 offen offset:2048 sc1
  buffer_load_dwordx4 v[60:63], v4, s[32:35], s75 offen offset:3072 sc1
F_ol_l1:
F_ol_mid:
  s_waitcnt vmcnt(0)
  s_bitcmp1_b32 s74, 0
  s_cbranch_scc1 F_ol_m0
  v_max3_u32 v108, v32, v33, v34
  v_max_u32 v108, v108, v35
  v_max3_u32 v108, v108, v36, v37
  v_max3_u32 v108, v108, v38, v39
  v_max3_u32 v108, v108, v40, v41
  v_max3_u32 v108, v108, v42, v43
  v_max3_u32 v108, v108, v44, v45
  v_max3_u32 v108, v108, v46, v47
  v_cmp_eq_u32 vcc, -1, v108
  s_cbranch_vccnz F_ol_m0
  v_mfma_f32_32x32x16_bf16 v[112:127], v[192:195], v[32:35], v[112:127]
  v_mfma_f32_32x32x16_bf16 v[128:143], v[196:199], v[32:35], v[128:143]
  v_mfma_f32_32x32x16_bf16 v[112:127], v[200:203], v[36:39], v[112:127]
  v_mfma_f32_32x32x16_bf16 v[128:143], v[204:207], v[36:39], v[128:143]
  v_mfma_f32_32x32x16_bf16 v[112:127], v[208:211], v[40:43], v[112:127]
  v_mfma_f32_32x32x16_bf16 v[128:143], v[212:215], v[40:43], v[128:143]
  v_mfma_f32_32x32x16_bf16 v[112:127], v[216:219], v[44:47], v[112:127]
  v_mfma_f32_32x32x16_bf16 v[128:143], v[220:223], v[44:47], v[128:143]
  s_bitset1_b32 s74, 0
F_ol_m0:
  s_bitcmp1_b32 s74, 1
  s_cbranch_scc1 F_ol_m1
  v_max3_u32 v108, v48, v49, v50
  v_max_u32 v108, v108, v51
  v_max3_u32 v108, v108, v52, v53
  v_max3_u32 v108, v108, v54, v55
  v_max3_u32 v108, v108, v56, v57
  v_max3_u32 v108, v108, v58, v59
  v_max3_u32 v108, v108, v60, v61
  v_max3_u32 v108, v108, v62, v63
  v_cmp_eq_u32 vcc, -1, v108
  s_cbranch_vccnz F_ol_m1
  v_mfma_f32_32x32x16_bf16 v[112:127], v[224:227], v[48:51], v[112:127]
  v_mfma_f32_32x32x16_bf16 v[128:143], v[228:231], v[48:51], v[128:143]
  v_mfma_f32_32x32x16_bf16 v[112:127], v[232:235], v[52:55], v[112:127]
  v_mfma_f32_32x32x16_bf16 v[128:143], v[236:239], v[52:55], v[128:143]
  v_mfma_f32_32x32x16_bf16 v[112:127], v[240:243], v[56:59], v[112:127]
  v_mfma_f32_32x32x16_bf16 v[128:143], v[244:247], v[56:59], v[128:143]
  v_mfma_f32_32x32x16_bf16 v[112:127], v[248:251], v[60:63], v[112:127]
  v_mfma_f32_32x32x16_bf16 v[128:143], v[252:255], v[60:63], v[128:143]
  s_bitset1_b32 s74, 1
F_ol_m1:
  s_cmp_eq_u32 s74, 3
  s_cbranch_scc1 F_ol_done
  s_sub_u32 s79, s79, 1
  s_cmp_lg_u32 s79, 0
  s_cbranch_scc1 F_ol_top
  s_bitcmp1_b32 s74, 0
  s_cbranch_scc1 F_ol_f0
  v_mfma_f32_32x32x16_bf16 v[112:127], v[192:195], v[32:35], v[112:127]
  v_mfma_f32_32x32x16_bf16 v[128:143], v[196:199], v[32:35], v[128:143]
  v_mfma_f32_32x32x16_bf16 v[112:127], v[200:203], v[36:39], v[112:127]
  v_mfma_f32_32x32x16_bf16 v[128:143], v[204:207], v[36:39], v[128:143]
  v_mfma_f32_32x32x16_bf16 v[112:127], v[208:211], v[40:43], v[112:127]
  v_mfma_f32_32x32x16_bf16 v[128:143], v[212:215], v[40:43], v[128:143]
  v_mfma_f32_32x32x16_bf16 v[112:127], v[216:219], v[44:47], v[112:127]
  v_mfma_f32_32x32x16_bf16 v[128:143], v[220:223], v[44:47], v[128:143]
F_ol_f0:
  s_bitcmp1_b32 s74, 1
  s_cbranch_scc1 F_ol_f1
  v_mfma_f32_32x32x16_bf16 v[112:127], v[224:227], v[48:51], v[112:127]
  v_mfma_f32_32x32x16_bf16 v[128:143], v[228:231], v[48:51], v[128:143]
  v_mfma_f32_32x32x16_bf16 v[112:127], v[232:235], v[52:55], v[112:127]
  v_mfma_f32_32x32x16_bf16 v[128:143], v[236:239], v[52:55], v[128:143]
  v_mfma_f32_32x32x16_bf16 v[112:127], v[240:243], v[56:59], v[112:127]
  v_mfma_f32_32x32x16_bf16 v[128:143], v[244:247], v[56:59], v[128:143]
  v_mfma_f32_32x32x16_bf16 v[112:127], v[248:251], v[60:63], v[112:127]
  v_mfma_f32_32x32x16_bf16 v[128:143], v[252:255], v[60:63], v[128:143]
F_ol_f1:
F_ol_done:
  s_cmp_ge_u32 s3, 2
  s_cbranch_scc1 F_rq2
  s_cmp_eq_u32 s3, 1
  s_cbranch_scc1 F_rq1
  s_nop 9
  ds_write_b128 v104, v[120:123] offset:8192
  ds_write_b128 v104, v[124:127] offset:9216
  s_nop 7
  ds_write_b128 v104, v[128:131] offset:16384
  ds_write_b128 v104, v[132:135] offset:17408
  ds_write_b128 v104, v[136:139] offset:24576
  ds_write_b128 v104, v[140:143] offset:25600
  s_waitcnt lgkmcnt(0)
  s_barrier
  ds_read_b128 v[32:35], v105 offset:2048
  ds_read_b128 v[36:39], v105 offset:3072
  ds_read_b128 v[40:43], v105 offset:4096
  ds_read_b128 v[44:47], v105 offset:5120
  ds_read_b128 v[48:51], v105 offset:6144
  ds_read_b128 v[52:55], v105 offset:7168
  s_waitcnt lgkmcnt(4)
  v_add_f32 v112, v112, v32
  v_add_f32 v113, v113, v33
  v_add_f32 v114, v114, v34
  v_add_f32 v115, v115, v35
  v_add_f32 v116, v116, v36
  v_add_f32 v117, v117, v37
  v_add_f32 v118, v118, v38
  v_add_f32 v119, v119, v39
  s_waitcnt lgkmcnt(2)
  v_add_f32 v112, v112, v40
  v_add_f32 v113, v113, v41
  v_add_f32 v114, v114, v42
  v_add_f32 v115, v115, v43
  v_add_f32 v116, v116, v44
  v_add_f32 v117, v117, v45
  v_add_f32 v118, v118, v46
  v_add_f32 v119, v119, v47
  s_waitcnt lgkmcnt(0)
  v_add_f32 v112, v112, v48
  v_add_f32 v113, v113, v49
  v_add_f32 v114, v114, v50
  v_add_f32 v115, v115, v51
  v_add_f32 v116, v116, v52
  v_add_f32 v117, v117, v53
  v_add_f32 v118, v118, v54
  v_add_f32 v119, v119, v55
  v_cvt_pk_bf16_f32 v60, v112, v113
  v_cvt_pk_bf16_f32 v61, v114, v115
  v_cvt_pk_bf16_f32 v62, v116, v117
  v_cvt_pk_bf16_f32 v63, v118, v119
  s_branch F_rqd
F_rq1:
  s_nop 9
  ds_write_b128 v104, v[112:115] offset:0
  ds_write_b128 v104, v[116:119] offset:1024
  s_nop 7
  ds_write_b128 v104, v[128:131] offset:16384
  ds_write_b128 v104, v[132:135] offset:17408
  ds_write_b128 v104, v[136:139] offset:24576
  ds_write_b128 v104, v[140:143] offset:25600
  s_waitcnt lgkmcnt(0)
  s_barrier
  ds_read_b128 v[32:35], v105 offset:0
  ds_read_b128 v[36:39], v105 offset:1024
  ds_read_b128 v[40:43], v105 offset:4096
  ds_read_b128 v[44:47], v105 offset:5120
  ds_read_b128 v[48:51], v105 offset:6144
  ds_read_b128 v[52:55], v105 offset:7168
  s_waitcnt lgkmcnt(4)
  v_add_f32 v120, v120, v32
  v_add_f32 v121, v121, v33
  v_add_f32 v122, v122, v34
  v_add_f32 v123, v123, v35
  v_add_f32 v124, v124, v36
  v_add_f32 v125, v125, v37
  v_add_f32 v126, v126, v38
  v_add_f32 v127, v127, v39
  s_waitcnt lgkmcnt(2)
  v_add_f32 v120, v120, v40
  v_add_f32 v121, v121, v41
  v_add_f32 v122, v122, v42
  v_add_f32 v123, v123, v43
  v_add_f32 v124, v124, v44
  v_add_f32 v125, v125, v45
  v_add_f32 v126, v126, v46
  v_add_f32 v127, v127, v47
  s_waitcnt lgkmcnt(0)
  v_add_f32 v120, v120, v48
  v_add_f32 v121, v121, v49
  v_add_f32 v122, v122, v50
  v_add_f32 v123, v123, v51
  v_add_f32 v124, v124, v52
  v_add_f32 v125, v125, v53
  v_add_f32 v126, v126, v54
  v_add_f32 v127, v127, v55
  v_cvt_pk_bf16_f32 v60, v120, v121
  v_cvt_pk_bf16_f32 v61, v122, v123
  v_cvt_pk_bf16_f32 v62, v124, v125
  v_cvt_pk_bf16_f32 v63, v126, v127
  s_branch F_rqd
F_rq2:
  s_cmp_eq_u32 s3, 3
  s_cbranch_scc1 F_rq3
  s_nop 9
  ds_write_b128 v104, v[112:115] offset:0
  ds_write_b128 v104, v[116:119] offset:1024
  ds_write_b128 v104, v[120:123] offset:8192
  ds_write_b128 v104, v[124:127] offset:9216
  s_nop 7
  ds_write_b128 v104, v[136:139] offset:24576
  ds_write_b128 v104, v[140:143] offset:25600
  s_waitcnt lgkmcnt(0)
  s_barrier
  ds_read_b128 v[32:35], v105 offset:0
  ds_read_b128 v[36:39], v105 offset:1024
  ds_read_b128 v[40:43], v105 offset:2048
  ds_read_b128 v[44:47], v105 offset:3072
  ds_read_b128 v[48:51], v105 offset:6144
  ds_read_b128 v[52:55], v105 offset:7168
  s_waitcnt lgkmcnt(4)
  v_add_f32 v128, v128, v32
  v_add_f32 v129, v129, v33
  v_add_f32 v130, v130, v34
  v_add_f32 v131, v131, v35
  v_add_f32 v132, v132, v36
  v_add_f32 v133, v133, v37
  v_add_f32 v134, v134, v38
  v_add_f32 v135, v135, v39
  s_waitcnt lgkmcnt(2)
  v_add_f32 v128, v128, v40
  v_add_f32 v129, v129, v41
  v_add_f32 v130, v130, v42
  v_add_f32 v131, v131, v43
  v_add_f32 v132, v132, v44
  v_add_f32 v133, v133, v45
  v_add_f32 v134, v134, v46
  v_add_f32 v135, v135, v47
  s_waitcnt lgkmcnt(0)
  v_add_f32 v128, v128, v48
  v_add_f32 v129, v129, v49
  v_add_f32 v130, v130, v50
  v_add_f32 v131, v131, v51
  v_add_f32 v132, v132, v52
  v_add_f32 v133, v133, v53
  v_add_f32 v134, v134, v54
  v_add_f32 v135, v135, v55
  v_cvt_pk_bf16_f32 v60, v128, v129
  v_cvt_pk_bf16_f32 v61, v130, v131
  v_cvt_pk_bf16_f32 v62, v132, v133
  v_cvt_pk_bf16_f32 v63, v134, v135
  s_branch F_rqd
F_rq3:
  s_nop 9
  ds_write_b128 v104, v[112:115] offset:0
  ds_write_b128 v104, v[116:119] offset:1024
  ds_write_b128 v104, v[120:123] offset:8192
  ds_write_b128 v104, v[124:127] offset:9216
  s_nop 7
  ds_write_b128 v104, v[128:131] offset:16384
  ds_write_b128 v104, v[132:135] offset:17408
  s_waitcnt lgkmcnt(0)
  s_barrier
  ds_read_b128 v[32:35], v105 offset:0
  ds_read_b128 v[36:39], v105 offset:1024
  ds_read_b128 v[40:43], v105 offset:2048
  ds_read_b128 v[44:47], v105 offset:3072
  ds_read_b128 v[48:51], v105 offset:4096
  ds_read_b128 v[52:55], v105 offset:5120
  s_waitcnt lgkmcnt(4)
  v_add_f32 v136, v136, v32
  v_add_f32 v137, v137, v33
  v_add_f32 v138, v138, v34
  v_add_f32 v139, v139, v35
  v_add_f32 v140, v140, v36
  v_add_f32 v141, v141, v37
  v_add_f32 v142, v142, v38
  v_add_f32 v143, v143, v39
  s_waitcnt lgkmcnt(2)
  v_add_f32 v136, v136, v40
  v_add_f32 v137, v137, v41
  v_add_f32 v138, v138, v42
  v_add_f32 v139, v139, v43
  v_add_f32 v140, v140, v44
  v_add_f32 v141, v141, v45
  v_add_f32 v142, v142, v46
  v_add_f32 v143, v143, v47
  s_waitcnt lgkmcnt(0)
  v_add_f32 v136, v136, v48
  v_add_f32 v137, v137, v49
  v_add_f32 v138, v138, v50
  v_add_f32 v139, v139, v51
  v_add_f32 v140, v140, v52
  v_add_f32 v141, v141, v53
  v_add_f32 v142, v142, v54
  v_add_f32 v143, v143, v55
  v_cvt_pk_bf16_f32 v60, v136, v137
  v_cvt_pk_bf16_f32 v61, v138, v139
  v_cvt_pk_bf16_f32 v62, v140, v141
  v_cvt_pk_bf16_f32 v63, v142, v143
F_rqd:
  s_nop 1
  v_permlane32_swap_b32 v60, v62
  v_permlane32_swap_b32 v61, v63
  buffer_store_dwordx4 v[60:63], v106, s[44:47], s77 offen
F_end:
  s_endpgm
F_slow:
  v_mov_b32 v5, v3
  v_mov_b32 v106, 0xff800000
  s_mov_b32 s57, 64
F_slow1:
  ds_read_b128 v[12:15], v5
  v_add_u32 v5, 2064, v5
  s_waitcnt lgkmcnt(0)
  v_mfma_f32_32x32x16_bf16 v[48:63], v[12:15], v[8:11], 0
  s_nop 15
  v_max3_f32 v106, v106, v48, v49
  v_max3_f32 v106, v106, v50, v51
  v_max3_f32 v106, v106, v52, v53
  v_max3_f32 v106, v106, v54, v55
  v_max3_f32 v106, v106, v56, v57
  v_max3_f32 v106, v106, v58, v59
  v_max3_f32 v106, v106, v60, v61
  v_max3_f32 v106, v106, v62, v63
  s_sub_u32 s57, s57, 1
  s_cmp_lg_u32 s57, 0
  s_cbranch_scc1 F_slow1
  v_mov_b32 v107, v106
  s_nop 1
  v_permlane32_swap_b32 v106, v107
  s_nop 0
  v_max_f32 v106, v106, v107
  v_sub_f32 v64, 0, v106
  v_sub_f32 v65, 0, v106
  v_sub_f32 v66, 0, v106
  v_sub_f32 v67, 0, v106
  v_sub_f32 v68, 0, v106
  v_sub_f32 v69, 0, v106
  v_sub_f32 v70, 0, v106
  v_sub_f32 v71, 0, v106
  v_sub_f32 v72, 0, v106
  v_sub_f32 v73, 0, v106
  v_sub_f32 v74, 0, v106
  v_sub_f32 v75, 0, v106
  v_sub_f32 v76, 0, v106
  v_sub_f32 v77, 0, v106
  v_sub_f32 v78, 0, v106
  v_sub_f32 v79, 0, v106
  s_nop 1
  v_mov_b32 v5, v3
  v_subrev_u32 v96, 99072, v96
  v_subrev_u32 v97, 99072, v97
  v_subrev_u32 v98, 99072, v98
  v_subrev_u32 v99, 99072, v99
  v_mov_b32 v80, 0
  v_mov_b32 v81, 0
  v_mov_b32 v82, 0
  v_mov_b32 v83, 0
  v_mov_b32 v84, 0
  v_mov_b32 v85, 0
  v_mov_b32 v86, 0
  v_mov_b32 v87, 0
  v_mov_b32 v88, 0
  v_mov_b32 v89, 0
  v_mov_b32 v90, 0
  v_mov_b32 v91, 0
  v_mov_b32 v92, 0
  v_mov_b32 v93, 0
  v_mov_b32 v94, 0
  v_mov_b32 v95, 0
  s_mov_b32 s57, 64
F_slow2:
  ds_read_b128 v[12:15], v5
  ds_read_b64_tr_b16 v[16:17], v96 offset:0
  ds_read_b64_tr_b16 v[18:19], v97 offset:0
  ds_read_b64_tr_b16 v[20:21], v98 offset:0
  ds_read_b64_tr_b16 v[22:23], v99 offset:0
  v_add_u32 v5, 2064, v5
  v_add_u32 v96, 2064, v96
  v_add_u32 v97, 2064, v97
  v_add_u32 v98, 2064, v98
  v_add_u32 v99, 2064, v99
  s_waitcnt lgkmcnt(0)
  v_mfma_f32_32x32x16_bf16 v[32:47], v[12:15], v[8:11], v[64:79]
  s_nop 15
  v_exp_f32 v32, v32
  v_exp_f32 v33, v33
  v_exp_f32 v34, v34
  v_exp_f32 v35, v35
  v_exp_f32 v36, v36
  v_exp_f32 v37, v37
  v_exp_f32 v38, v38
  v_exp_f32 v39, v39
  v_exp_f32 v40, v40
  v_exp_f32 v41, v41
  v_exp_f32 v42, v42
  v_exp_f32 v43, v43
  v_exp_f32 v44, v44
  v_exp_f32 v45, v45
  v_exp_f32 v46, v46
  v_exp_f32 v47, v47
  s_nop 1
  v_smfmac_f32_32x32x32_bf16 v[80:95], v[16:19], v[32:39], v28
  v_smfmac_f32_32x32x32_bf16 v[80:95], v[20:23], v[40:47], v28
  s_sub_u32 s57, s57, 1
  s_cmp_lg_u32 s57, 0
  s_cbranch_scc1 F_slow2
  s_nop 15
  s_branch F_fin
F_last:
.section .rodata,"a"
.p2align 6
.amdhsa_kernel gated_mix__softmax_full_mha__dense_activation_silu__prompt_kernel
  .amdhsa_next_free_vgpr 256
  .amdhsa_next_free_sgpr 102
  .amdhsa_accum_offset 256
  .amdhsa_group_segment_fixed_size 0
  .amdhsa_kernarg_size 80
  .amdhsa_user_sgpr_count 2
  .amdhsa_user_sgpr_kernarg_segment_ptr 1
  .amdhsa_system_sgpr_workgroup_id_x 1
  .amdhsa_float_denorm_mode_32 3
.end_amdhsa_kernel
```
